```python
import torch

def _softmax(x, axis=-1):
    return torch.softmax(x, dim=axis)

def _gelu(x):
    return torch.nn.functional.gelu(x, approximate='tanh')

def _silu(x):
    return torch.nn.functional.silu(x)

def _sigmoid(x):
    return torch.sigmoid(x)

def _layernorm(x, axis=-1, eps=1e-05):
    m = x.mean(dim=axis, keepdim=True)
    v = x.var(dim=axis, keepdim=True, unbiased=False)
    return (x - m) / torch.sqrt(v + eps)

def _scatter_add(tgt, idx, src, axis=0):
    return tgt.clone().index_add_(axis, idx, src)

def _segment_sum(src, seg, n):
    out = torch.zeros((n,) + src.shape[1:], dtype=src.dtype)
    return out.index_add_(0, seg, src)

def _pad(x, pw):
    flat = tuple((v for pair in reversed(pw) for v in pair))
    return torch.nn.functional.pad(x, flat)
kernel_name = 'adaLN_cond__mha_block__moe_arch_mod__prompt'

def setup_inputs():

    _w = lambda a: (lambda t: t.to(torch.bfloat16) if t.is_floating_point() else t)(torch.as_tensor(a))

    def _A_setup():
        B, S, D, H = (1, 2048, 512, 32)
        return {'x': _w((lambda *s: torch.randn(*s, dtype=torch.bfloat16) * 0.05)(B, S, D)), 'wqkv': _w((lambda *s: torch.randn(*s, dtype=torch.bfloat16) * 0.05)(D, 3 * D)), 'wo': _w((lambda *s: torch.randn(*s, dtype=torch.bfloat16) * 0.05)(D, D))}
    _A_in = _A_setup()

    def _B_setup():
        B, S, D, F, C = (1, 2048, 512, 1792, 2)
        return {'x': _w((lambda *s: torch.randn(*s, dtype=torch.bfloat16) * 0.05)(B, S, D)), 'w_r': _w((lambda *s: torch.randn(*s, dtype=torch.bfloat16) * 0.05)(D)), 'w_gate': _w((lambda *s: torch.randn(*s, dtype=torch.bfloat16) * 0.05)(D, F)), 'w_up': _w((lambda *s: torch.randn(*s, dtype=torch.bfloat16) * 0.05)(D, F)), 'w_down': _w((lambda *s: torch.randn(*s, dtype=torch.bfloat16) * 0.05)(F, D))}
    _B_in = _B_setup()
    return {'A_x': _A_in['x'], 'A_wqkv': _A_in['wqkv'], 'A_wo': _A_in['wo'], 'B_x': _B_in['x'], 'B_w_r': _B_in['w_r'], 'B_w_gate': _B_in['w_gate'], 'B_w_up': _B_in['w_up'], 'B_w_down': _B_in['w_down'], 'c': _w((lambda *s: torch.randn(*s, dtype=torch.bfloat16) * 0.1)(1, 512) * 8.0), 'w_mod': _w((lambda *s: torch.randn(*s, dtype=torch.bfloat16) * 0.1)(512, 6 * 512) * 512 ** (-0.5) * 8.0)}

def reference(A_x, A_wqkv, A_wo, B_x, B_w_r, B_w_gate, B_w_up, B_w_down, c, w_mod):

    def _A_ref(x, wqkv, wo):
        B, S, D = x.shape
        H = 32
        Dh = D // H
        qkv = (lambda x, *d: x.permute(*d))((x @ wqkv).reshape(B, S, 3, H, Dh), 2, 0, 3, 1, 4)
        q, k, v = (qkv[0], qkv[1], qkv[2])
        scores = torch.einsum('bhqd,bhkd->bhqk', q, k) * Dh ** (-0.5)
        p = _softmax(scores, axis=-1)
        o = torch.einsum('bhqk,bhkd->bhqd', p, v)
        return (lambda x, *d: x.permute(*d))(o, 0, 2, 1, 3).reshape(B, S, D) @ wo

    def _B_ref(x, w_r, w_gate, w_up, w_down):
        B, S, D = x.shape
        C = 2
        r = x @ w_r
        idx = torch.argsort(-r, axis=-1)[:, :C]
        idx_e = (lambda x, n, axis: torch.repeat_interleave(x, n, dim=axis))(idx.reshape(B, C, 1), D, axis=2)
        x_sel = (lambda x, i, axis: torch.take_along_dim(x, i, dim=axis))(x, idx_e, axis=1)
        g = _silu(x_sel @ w_gate)
        u = x_sel @ w_up
        y = g * u @ w_down
        r_sel = _sigmoid((lambda x, i, axis: torch.take_along_dim(x, i, dim=axis))(r, idx, axis=1))
        y = y * r_sel.reshape(B, C, 1)
        b_off = (torch.arange(B) * S).reshape(B, 1)
        flat_idx = (idx + b_off).reshape(B * C)
        zero = (x * 0.0).reshape(B * S, D)
        upd = _scatter_add(zero, flat_idx, y.reshape(B * C, D), axis=0)
        return x + upd.reshape(B, S, D)
    x = A_x
    mod = (_silu(c) @ w_mod).reshape(c.shape[0], 6, 1, -1)
    sa, ca, ga, sb, cb, gb = (mod[:, 0].clone(), mod[:, 1].clone(), mod[:, 2].clone(), mod[:, 3].clone(), mod[:, 4].clone(), mod[:, 5].clone())
    h = _layernorm(x, axis=-1) * (1 + ca) + sa
    x = x + ga * _A_ref(h, A_wqkv, A_wo)
    h = _layernorm(x, axis=-1) * (1 + cb) + sb
    x = x + gb * _B_ref(h, B_w_r, B_w_gate, B_w_up, B_w_down)
    return x
```

```asm
; @launch kernel=k2_kernel grid=(256,1,1) block=(576,1,1) lds=163840
; @launch kernel=k5_kernel grid=(256,1,1) block=(512,1,1) lds=39936
.amdgcn_target "amdgcn-amd-amdhsa--gfx950"

.text
.globl k2_kernel
.p2align 8
.type k2_kernel,@function
k2_kernel:
    s_cmp_ge_u32 s2, 256
    s_cbranch_scc1 K2_END
    s_load_dwordx4 s[40:43], s[0:1], 64
    s_load_dwordx4 s[4:7], s[0:1], 0
    s_load_dwordx4 s[44:47], s[0:1], 88
    s_getpc_b64 s[48:49]
K2_PC:
    s_sub_u32 s48, s48, K2_PC-k2_kernel
    s_subb_u32 s49, s49, 0
    s_mov_b32 s50, K3_ENTRY-k2_kernel
    s_mov_b32 s51, 0x20000
    v_lshlrev_b32 v1, 7, v0
    buffer_load_dword v166, v1, s[48:51], 0 offen
    v_lshrrev_b32 v1, 3, v0
    v_and_b32 v2, 7, v0
    v_mul_u32_u24 v3, 6144, v1
    v_lshl_add_u32 v3, v2, 4, v3
    v_lshlrev_b32 v4, 1, v1
    s_and_b32 s29, s2, 15
    s_lshr_b32 s30, s2, 4
    s_mul_i32 s31, s30, 786432
    s_lshl_b32 s32, s29, 7
    s_add_u32 s31, s31, s32
    s_add_u32 s32, s31, 393216
    s_lshl_b32 s34, s30, 8
    s_mov_b32 s38, 1024
    s_mov_b32 s39, 0x20000
    s_cmp_ge_u32 s2, 64
    s_waitcnt lgkmcnt(0)
    s_mov_b32 s36, s40
    s_mov_b32 s37, s41
    s_mov_b32 s40, s42
    s_mov_b32 s41, s43
    s_mov_b32 s42, 3145728
    s_mov_b32 s43, 0x20000
    s_cbranch_scc1 K2_E1
    buffer_load_dwordx4 v[12:15], v3, s[40:43], s31 offen
    buffer_load_dwordx4 v[16:19], v3, s[40:43], s32 offen
    buffer_load_ushort v8, v4, s[36:39], s34 offen offset:0
    buffer_load_ushort v9, v4, s[36:39], s34 offen offset:128
K2_E1:
    v_readfirstlane_b32 s22, v0
    s_lshr_b32 s22, s22, 6
    v_and_b32 v160, 63, v0
    v_lshlrev_b32 v161, 4, v160
    s_mov_b32 s12, s4
    s_mov_b32 s13, s5
    s_mov_b32 s14, 2097152
    s_mov_b32 s15, 0x20000
    s_mov_b32 s8, s46
    s_mov_b32 s9, s47
    s_mov_b32 s10, 23068672
    s_mov_b32 s11, 0x20000
    s_mov_b32 s16, s6
    s_mov_b32 s17, s7
    s_mov_b32 s18, 1572864
    s_mov_b32 s19, 0x20000
    s_mov_b32 s46, 256
    s_mov_b32 s47, 0x20000
    s_and_b32 s35, s22, 3
    s_and_b32 s23, s22, 1
    s_lshr_b32 s24, s35, 1
    v_and_b32 v163, 3, v160
    s_mul_i32 s28, s23, 49152
    s_add_u32 s28, s28, 65536
    s_mov_b32 s79, 0
    s_cmp_eq_u32 s22, 8
    s_cbranch_scc1 K2_W8
    v_mov_b32 v40, 0
    s_mov_b32 s48, 47104
    buffer_load_dword v165, v40, s[8:11], s48 offen sc1
    s_cmp_ge_u32 s2, 64
    s_cbranch_scc1 K2_NURG
    v_lshrrev_b32 v5, 4, v0
    v_lshlrev_b32 v5, 8, v5
    v_lshl_add_u32 v5, v2, 5, v5
    s_waitcnt vmcnt(1)
    v_lshlrev_b32 v8, 16, v8
    v_lshlrev_b32 v9, 16, v9
    v_mul_f32 v28, 0xbfb8aa3b, v8
    v_mul_f32 v29, 0xbfb8aa3b, v9
    v_exp_f32 v28, v28
    v_exp_f32 v29, v29
    s_nop 0
    v_add_f32 v28, 1.0, v28
    v_add_f32 v29, 1.0, v29
    v_rcp_f32 v28, v28
    v_rcp_f32 v29, v29
    s_nop 0
    v_mul_f32 v8, v8, v28
    v_mul_f32 v9, v9, v29
    v_cvt_pk_bf16_f32 v8, v8, v8
    v_cvt_pk_bf16_f32 v9, v9, v9
    v_and_b32 v8, 0xffff0000, v8
    v_and_b32 v9, 0xffff0000, v9
    v_lshlrev_b32 v28, 16, v12
    v_and_b32 v29, 0xffff0000, v12
    v_mul_f32 v32, v28, v8
    v_mul_f32 v33, v29, v8
    v_lshlrev_b32 v28, 16, v13
    v_and_b32 v29, 0xffff0000, v13
    v_mul_f32 v34, v28, v8
    v_mul_f32 v35, v29, v8
    v_lshlrev_b32 v28, 16, v14
    v_and_b32 v29, 0xffff0000, v14
    v_mul_f32 v36, v28, v8
    v_mul_f32 v37, v29, v8
    v_lshlrev_b32 v28, 16, v15
    v_and_b32 v29, 0xffff0000, v15
    v_mul_f32 v38, v28, v8
    v_mul_f32 v39, v29, v8
    v_lshlrev_b32 v28, 16, v16
    v_and_b32 v29, 0xffff0000, v16
    v_fmac_f32 v32, v28, v9
    v_fmac_f32 v33, v29, v9
    v_lshlrev_b32 v28, 16, v17
    v_and_b32 v29, 0xffff0000, v17
    v_fmac_f32 v34, v28, v9
    v_fmac_f32 v35, v29, v9
    v_lshlrev_b32 v28, 16, v18
    v_and_b32 v29, 0xffff0000, v18
    v_fmac_f32 v36, v28, v9
    v_fmac_f32 v37, v29, v9
    v_lshlrev_b32 v28, 16, v19
    v_and_b32 v29, 0xffff0000, v19
    v_fmac_f32 v38, v28, v9
    v_fmac_f32 v39, v29, v9
    s_nop 0
    v_add_f32_dpp v32, v32, v32 row_ror:8 row_mask:0xf bank_mask:0xf
    v_add_f32_dpp v33, v33, v33 row_ror:8 row_mask:0xf bank_mask:0xf
    v_add_f32_dpp v34, v34, v34 row_ror:8 row_mask:0xf bank_mask:0xf
    v_add_f32_dpp v35, v35, v35 row_ror:8 row_mask:0xf bank_mask:0xf
    v_add_f32_dpp v36, v36, v36 row_ror:8 row_mask:0xf bank_mask:0xf
    v_add_f32_dpp v37, v37, v37 row_ror:8 row_mask:0xf bank_mask:0xf
    v_add_f32_dpp v38, v38, v38 row_ror:8 row_mask:0xf bank_mask:0xf
    v_add_f32_dpp v39, v39, v39 row_ror:8 row_mask:0xf bank_mask:0xf
    s_mov_b32 exec_lo, 0x00ff00ff
    s_mov_b32 exec_hi, 0x00ff00ff
    ds_write_b128 v5, v[32:35]
    ds_write_b128 v5, v[36:39] offset:16
    s_mov_b64 exec, -1
    s_waitcnt lgkmcnt(0)
    s_barrier
    s_cmp_lg_u32 s22, 0
    s_cbranch_scc1 K2_XL
    v_and_b32 v6, 15, v160
    v_lshlrev_b32 v6, 4, v6
    v_lshrrev_b32 v7, 4, v160
    v_lshl_add_u32 v7, v7, 11, v6
    ds_read_b128 v[8:11], v7 offset:0
    ds_read_b128 v[12:15], v7 offset:256
    ds_read_b128 v[16:19], v7 offset:512
    ds_read_b128 v[20:23], v7 offset:768
    ds_read_b128 v[24:27], v7 offset:1024
    ds_read_b128 v[28:31], v7 offset:1280
    ds_read_b128 v[32:35], v7 offset:1536
    ds_read_b128 v[36:39], v7 offset:1792
    s_lshl_b32 s31, s30, 12
    s_lshl_b32 s32, s29, 8
    s_add_u32 s31, s31, s32
    s_add_u32 s31, s31, 524288
    s_mov_b32 s32, 0xffffff00
    s_mov_b32 s34, 0x07060503
    s_mov_b32 s48, 0x07060502
    s_mov_b32 s49, 0x07060501
    s_waitcnt vmcnt(0) lgkmcnt(0)
    v_pk_add_f32 v[8:9], v[8:9], v[24:25]
    v_pk_add_f32 v[10:11], v[10:11], v[26:27]
    v_pk_add_f32 v[12:13], v[12:13], v[28:29]
    v_pk_add_f32 v[14:15], v[14:15], v[30:31]
    v_pk_add_f32 v[16:17], v[16:17], v[32:33]
    v_pk_add_f32 v[18:19], v[18:19], v[34:35]
    v_pk_add_f32 v[20:21], v[20:21], v[36:37]
    v_pk_add_f32 v[22:23], v[22:23], v[38:39]
    v_pk_add_f32 v[8:9], v[8:9], v[16:17]
    v_pk_add_f32 v[10:11], v[10:11], v[18:19]
    v_pk_add_f32 v[12:13], v[12:13], v[20:21]
    v_pk_add_f32 v[14:15], v[14:15], v[22:23]
    v_pk_add_f32 v[8:9], v[8:9], v[12:13]
    v_pk_add_f32 v[10:11], v[10:11], v[14:15]
    v_mov_b32 v12, v8
    v_mov_b32 v13, v9
    v_mov_b32 v14, v10
    v_mov_b32 v15, v11
    v_permlane16_swap_b32 v8, v12
    v_permlane16_swap_b32 v9, v13
    v_permlane16_swap_b32 v10, v14
    v_permlane16_swap_b32 v11, v15
    v_pk_add_f32 v[8:9], v[8:9], v[12:13]
    v_pk_add_f32 v[10:11], v[10:11], v[14:15]
    v_mov_b32 v12, v8
    v_mov_b32 v13, v9
    v_mov_b32 v14, v10
    v_mov_b32 v15, v11
    v_permlane32_swap_b32 v8, v12
    v_permlane32_swap_b32 v9, v13
    v_permlane32_swap_b32 v10, v14
    v_permlane32_swap_b32 v11, v15
    v_pk_add_f32 v[8:9], v[8:9], v[12:13]
    v_pk_add_f32 v[10:11], v[10:11], v[14:15]
    v_perm_b32 v8, v8, v11, s34
    v_perm_b32 v9, v9, v11, s48
    v_perm_b32 v10, v10, v11, s49
    v_add_u32 v11, 1, v165
    v_max_u32 v11, 1, v11
    s_mov_b64 exec, 0xffff
    buffer_store_dwordx4 v[8:11], v6, s[8:11], s31 offen sc1
    s_mov_b64 exec, -1
    s_mov_b32 s79, 1
    s_branch K2_XL
K2_NURG:
K2_XL:
K2_RV:
    s_mov_b32 s6, s2
    s_and_b32 s3, s6, 7
    s_lshr_b32 s33, s6, 3
    s_lshr_b32 s21, s3, 1
    s_lshl_b32 s21, s21, 3
    s_and_b32 s34, s33, 7
    s_add_u32 s21, s21, s34
    s_lshl_b32 s25, s21, 3
    s_add_u32 s25, s25, s22
    s_lshl_b32 s25, s25, 13
    s_add_u32 s26, s25, 4096
    buffer_load_dwordx4 v[48:51], v161, s[12:15], s25 offen offset:0
    buffer_load_dwordx4 v[52:55], v161, s[12:15], s25 offen offset:1024
    buffer_load_dwordx4 v[56:59], v161, s[12:15], s25 offen offset:2048
    buffer_load_dwordx4 v[60:63], v161, s[12:15], s25 offen offset:3072
    buffer_load_dwordx4 v[64:67], v161, s[12:15], s26 offen offset:0
    buffer_load_dwordx4 v[68:71], v161, s[12:15], s26 offen offset:1024
    buffer_load_dwordx4 v[72:75], v161, s[12:15], s26 offen offset:2048
    buffer_load_dwordx4 v[76:79], v161, s[12:15], s26 offen offset:3072
K2_XLD:
    s_and_b32 s20, s3, 1
    s_lshl_b32 s20, s20, 2
    s_lshr_b32 s34, s33, 3
    s_add_u32 s20, s20, s34
    v_bfe_u32 v162, v160, 4, 1
    v_mul_u32_u24 v162, 3072, v162
    v_bfe_u32 v13, v160, 2, 2
    v_lshl_add_u32 v162, v13, 10, v162
    v_lshl_add_u32 v162, v163, 7, v162
    s_lshl_b32 s34, s33, 2
    s_add_u32 s34, s34, s35
    s_mul_i32 s34, s34, 6144
    s_and_b32 s31, s3, 1
    s_lshl_b32 s31, s31, 9
    s_add_u32 s69, s34, s31
    s_add_u32 s70, s69, 786432
    v_lshrrev_b32 v16, 1, v160
    v_lshlrev_b32 v16, 10, v16
    v_and_b32 v17, 1, v160
    v_lshl_add_u32 v16, v17, 9, v16
    v_and_b32 v17, 7, v160
    v_lshl_add_u32 v16, v17, 4, v16
    s_lshr_b32 s31, s22, 2
    s_lshl_b32 s31, s31, 15
    s_lshl_b32 s32, s35, 7
    s_add_u32 s31, s31, s32
    v_add_u32 v164, s31, v16
    v_lshlrev_b32 v167, 5, v160
    v_add_u32 v167, 159744, v167
    s_mov_b32 s31, 0x3f803f80
    s_cmp_lt_u32 s22, 4
    s_cbranch_scc1 K2_P1X
    buffer_load_dword v166, v162, s[16:19], s69 offen
    s_waitcnt vmcnt(1)
    s_branch K2_XOK
K2_P1X:
    s_waitcnt vmcnt(0)
K2_XOK:
    v_readfirstlane_b32 s64, v165
    s_add_u32 s64, s64, 1
    s_max_u32 s64, s64, 1
    s_cmp_ge_u32 s22, 4
    s_cbranch_scc1 K2_NGO
    v_mov_b32 v11, 0
    buffer_load_dword v31, v11, s[44:47], 0 offen offset:128 sc1
K2_NGO:
    s_cmp_lt_u32 s22, 4
    s_cbranch_scc1 K2_NPF1
    s_sub_u32 s76, s2, 64
    s_and_b32 s77, s76, 31
    s_add_u32 s77, s77, 16
    s_lshr_b32 s78, s76, 5
    s_lshl_b32 s78, s78, 2
    s_add_u32 s78, s78, s35
    v_lshrrev_b32 v1, 3, v160
    v_and_b32 v2, 7, v160
    v_mul_u32_u24 v3, 6144, v1
    v_lshl_add_u32 v3, v2, 4, v3
    v_lshlrev_b32 v4, 1, v1
    s_mul_i32 s71, s78, 196608
    s_lshl_b32 s72, s77, 7
    s_add_u32 s71, s71, s72
    s_add_u32 s72, s71, 49152
    s_add_u32 s73, s71, 98304
    s_add_u32 s74, s71, 147456
    s_lshl_b32 s75, s78, 6
    s_cmp_lt_u32 s76, 128
    s_cbranch_scc0 K2_NPF1
    buffer_load_ushort v8, v4, s[36:39], s75 offen offset:0
    buffer_load_ushort v9, v4, s[36:39], s75 offen offset:16
    buffer_load_ushort v10, v4, s[36:39], s75 offen offset:32
    buffer_load_ushort v11, v4, s[36:39], s75 offen offset:48
    buffer_load_dwordx4 v[12:15], v3, s[40:43], s71 offen
    buffer_load_dwordx4 v[16:19], v3, s[40:43], s72 offen
    buffer_load_dwordx4 v[20:23], v3, s[40:43], s73 offen
    buffer_load_dwordx4 v[24:27], v3, s[40:43], s74 offen
K2_NPF1:
    v_dot2_f32_bf16 v32, v48, s31, 0
    v_dot2_f32_bf16 v40, v48, v48, 0
    v_dot2_f32_bf16 v33, v52, s31, 0
    v_dot2_f32_bf16 v41, v52, v52, 0
    v_dot2_f32_bf16 v34, v56, s31, 0
    v_dot2_f32_bf16 v42, v56, v56, 0
    v_dot2_f32_bf16 v35, v60, s31, 0
    v_dot2_f32_bf16 v43, v60, v60, 0
    v_dot2_f32_bf16 v36, v64, s31, 0
    v_dot2_f32_bf16 v44, v64, v64, 0
    v_dot2_f32_bf16 v37, v68, s31, 0
    v_dot2_f32_bf16 v45, v68, v68, 0
    v_dot2_f32_bf16 v38, v72, s31, 0
    v_dot2_f32_bf16 v46, v72, v72, 0
    v_dot2_f32_bf16 v39, v76, s31, 0
    v_dot2_f32_bf16 v47, v76, v76, 0
    v_dot2_f32_bf16 v32, v49, s31, v32
    v_dot2_f32_bf16 v40, v49, v49, v40
    v_dot2_f32_bf16 v33, v53, s31, v33
    v_dot2_f32_bf16 v41, v53, v53, v41
    v_dot2_f32_bf16 v34, v57, s31, v34
    v_dot2_f32_bf16 v42, v57, v57, v42
    v_dot2_f32_bf16 v35, v61, s31, v35
    v_dot2_f32_bf16 v43, v61, v61, v43
    v_dot2_f32_bf16 v36, v65, s31, v36
    v_dot2_f32_bf16 v44, v65, v65, v44
    v_dot2_f32_bf16 v37, v69, s31, v37
    v_dot2_f32_bf16 v45, v69, v69, v45
    v_dot2_f32_bf16 v38, v73, s31, v38
    v_dot2_f32_bf16 v46, v73, v73, v46
    v_dot2_f32_bf16 v39, v77, s31, v39
    v_dot2_f32_bf16 v47, v77, v77, v47
    v_dot2_f32_bf16 v32, v50, s31, v32
    v_dot2_f32_bf16 v40, v50, v50, v40
    v_dot2_f32_bf16 v33, v54, s31, v33
    v_dot2_f32_bf16 v41, v54, v54, v41
    v_dot2_f32_bf16 v34, v58, s31, v34
    v_dot2_f32_bf16 v42, v58, v58, v42
    v_dot2_f32_bf16 v35, v62, s31, v35
    v_dot2_f32_bf16 v43, v62, v62, v43
    v_dot2_f32_bf16 v36, v66, s31, v36
    v_dot2_f32_bf16 v44, v66, v66, v44
    v_dot2_f32_bf16 v37, v70, s31, v37
    v_dot2_f32_bf16 v45, v70, v70, v45
    v_dot2_f32_bf16 v38, v74, s31, v38
    v_dot2_f32_bf16 v46, v74, v74, v46
    v_dot2_f32_bf16 v39, v78, s31, v39
    v_dot2_f32_bf16 v47, v78, v78, v47
    v_dot2_f32_bf16 v32, v51, s31, v32
    v_dot2_f32_bf16 v40, v51, v51, v40
    v_dot2_f32_bf16 v33, v55, s31, v33
    v_dot2_f32_bf16 v41, v55, v55, v41
    v_dot2_f32_bf16 v34, v59, s31, v34
    v_dot2_f32_bf16 v42, v59, v59, v42
    v_dot2_f32_bf16 v35, v63, s31, v35
    v_dot2_f32_bf16 v43, v63, v63, v43
    v_dot2_f32_bf16 v36, v67, s31, v36
    v_dot2_f32_bf16 v44, v67, v67, v44
    v_dot2_f32_bf16 v37, v71, s31, v37
    v_dot2_f32_bf16 v45, v71, v71, v45
    v_dot2_f32_bf16 v38, v75, s31, v38
    v_dot2_f32_bf16 v46, v75, v75, v46
    v_dot2_f32_bf16 v39, v79, s31, v39
    v_dot2_f32_bf16 v47, v79, v79, v47
    s_nop 2
    v_permlane32_swap_b32 v32, v36
    v_permlane32_swap_b32 v33, v37
    v_permlane32_swap_b32 v34, v38
    v_permlane32_swap_b32 v35, v39
    v_permlane32_swap_b32 v40, v44
    v_permlane32_swap_b32 v41, v45
    v_permlane32_swap_b32 v42, v46
    v_permlane32_swap_b32 v43, v47
    v_add_f32 v32, v32, v36
    v_add_f32 v33, v33, v37
    v_add_f32 v34, v34, v38
    v_add_f32 v35, v35, v39
    v_add_f32 v40, v40, v44
    v_add_f32 v41, v41, v45
    v_add_f32 v42, v42, v46
    v_add_f32 v43, v43, v47
    s_nop 0
    v_permlane16_swap_b32 v32, v34
    v_permlane16_swap_b32 v33, v35
    v_permlane16_swap_b32 v40, v42
    v_permlane16_swap_b32 v41, v43
    v_add_f32 v32, v32, v34
    v_add_f32 v33, v33, v35
    v_add_f32 v40, v40, v42
    v_add_f32 v41, v41, v43
    v_add_f32_dpp v32, v32, v32 quad_perm:[1,0,3,2] row_mask:0xf bank_mask:0xf
    v_add_f32_dpp v33, v33, v33 quad_perm:[1,0,3,2] row_mask:0xf bank_mask:0xf
    v_add_f32_dpp v40, v40, v40 quad_perm:[1,0,3,2] row_mask:0xf bank_mask:0xf
    v_add_f32_dpp v41, v41, v41 quad_perm:[1,0,3,2] row_mask:0xf bank_mask:0xf
    v_add_f32_dpp v32, v32, v32 quad_perm:[2,3,0,1] row_mask:0xf bank_mask:0xf
    v_add_f32_dpp v33, v33, v33 quad_perm:[2,3,0,1] row_mask:0xf bank_mask:0xf
    v_add_f32_dpp v40, v40, v40 quad_perm:[2,3,0,1] row_mask:0xf bank_mask:0xf
    v_add_f32_dpp v41, v41, v41 quad_perm:[2,3,0,1] row_mask:0xf bank_mask:0xf
    v_add_f32_dpp v32, v32, v32 row_ror:4 row_mask:0xf bank_mask:0xf
    v_add_f32_dpp v33, v33, v33 row_ror:4 row_mask:0xf bank_mask:0xf
    v_add_f32_dpp v40, v40, v40 row_ror:4 row_mask:0xf bank_mask:0xf
    v_add_f32_dpp v41, v41, v41 row_ror:4 row_mask:0xf bank_mask:0xf
    v_add_f32_dpp v32, v32, v32 row_ror:8 row_mask:0xf bank_mask:0xf
    v_add_f32_dpp v33, v33, v33 row_ror:8 row_mask:0xf bank_mask:0xf
    v_add_f32_dpp v40, v40, v40 row_ror:8 row_mask:0xf bank_mask:0xf
    v_add_f32_dpp v41, v41, v41 row_ror:8 row_mask:0xf bank_mask:0xf
    v_mul_f32 v32, 0x3b000000, v32
    v_mul_f32 v33, 0x3b000000, v33
    v_mul_f32 v40, 0x3b000000, v40
    v_mul_f32 v41, 0x3b000000, v41
    v_fma_f32 v40, -v32, v32, v40
    v_fma_f32 v41, -v33, v33, v41
    v_max_f32 v40, 0, v40
    v_max_f32 v41, 0, v41
    v_cvt_pk_bf16_f32 v32, v32, v32
    v_cvt_pk_bf16_f32 v33, v33, v33
    v_cvt_pk_bf16_f32 v40, v40, v40
    v_cvt_pk_bf16_f32 v41, v41, v41
    v_and_b32 v32, 0xffff0000, v32
    v_and_b32 v33, 0xffff0000, v33
    v_and_b32 v40, 0xffff0000, v40
    v_and_b32 v41, 0xffff0000, v41
    v_add_f32 v40, 0x3727c5ac, v40
    v_add_f32 v41, 0x3727c5ac, v41
    v_cvt_pk_bf16_f32 v40, v40, v40
    v_cvt_pk_bf16_f32 v41, v41, v41
    v_and_b32 v40, 0xffff0000, v40
    v_and_b32 v41, 0xffff0000, v41
    v_sqrt_f32 v40, v40
    v_sqrt_f32 v41, v41
    s_nop 0
    v_cvt_pk_bf16_f32 v40, v40, v40
    v_cvt_pk_bf16_f32 v41, v41, v41
    v_and_b32 v40, 0xffff0000, v40
    v_and_b32 v41, 0xffff0000, v41
    v_rcp_f32 v40, v40
    v_rcp_f32 v41, v41
    s_nop 0
    v_mul_f32 v32, -v32, v40
    v_mul_f32 v33, -v33, v41
    s_nop 0
    v_readlane_b32 s48, v40, 0
    v_readlane_b32 s49, v32, 0
    v_readlane_b32 s50, v41, 0
    v_readlane_b32 s51, v33, 0
    v_readlane_b32 s52, v40, 16
    v_readlane_b32 s53, v32, 16
    v_readlane_b32 s54, v41, 16
    v_readlane_b32 s55, v33, 16
    v_readlane_b32 s56, v40, 32
    v_readlane_b32 s57, v32, 32
    v_readlane_b32 s58, v41, 32
    v_readlane_b32 s59, v33, 32
    v_readlane_b32 s60, v40, 48
    v_readlane_b32 s61, v32, 48
    v_readlane_b32 s62, v41, 48
    v_readlane_b32 s63, v33, 48
    v_lshlrev_b32 v80, 16, v48
    v_and_b32 v81, 0xffff0000, v48
    v_lshlrev_b32 v82, 16, v49
    v_and_b32 v83, 0xffff0000, v49
    v_lshlrev_b32 v84, 16, v50
    v_and_b32 v85, 0xffff0000, v50
    v_lshlrev_b32 v86, 16, v51
    v_and_b32 v87, 0xffff0000, v51
    v_pk_fma_f32 v[80:81], v[80:81], s[48:49], s[48:49] op_sel:[0,0,1] op_sel_hi:[1,0,1]
    v_pk_fma_f32 v[82:83], v[82:83], s[48:49], s[48:49] op_sel:[0,0,1] op_sel_hi:[1,0,1]
    v_pk_fma_f32 v[84:85], v[84:85], s[48:49], s[48:49] op_sel:[0,0,1] op_sel_hi:[1,0,1]
    v_pk_fma_f32 v[86:87], v[86:87], s[48:49], s[48:49] op_sel:[0,0,1] op_sel_hi:[1,0,1]
    v_lshlrev_b32 v88, 16, v52
    v_and_b32 v89, 0xffff0000, v52
    v_lshlrev_b32 v90, 16, v53
    v_and_b32 v91, 0xffff0000, v53
    v_lshlrev_b32 v92, 16, v54
    v_and_b32 v93, 0xffff0000, v54
    v_lshlrev_b32 v94, 16, v55
    v_and_b32 v95, 0xffff0000, v55
    v_pk_fma_f32 v[88:89], v[88:89], s[50:51], s[50:51] op_sel:[0,0,1] op_sel_hi:[1,0,1]
    v_pk_fma_f32 v[90:91], v[90:91], s[50:51], s[50:51] op_sel:[0,0,1] op_sel_hi:[1,0,1]
    v_pk_fma_f32 v[92:93], v[92:93], s[50:51], s[50:51] op_sel:[0,0,1] op_sel_hi:[1,0,1]
    v_pk_fma_f32 v[94:95], v[94:95], s[50:51], s[50:51] op_sel:[0,0,1] op_sel_hi:[1,0,1]
    v_lshlrev_b32 v96, 16, v56
    v_and_b32 v97, 0xffff0000, v56
    v_lshlrev_b32 v98, 16, v57
    v_and_b32 v99, 0xffff0000, v57
    v_lshlrev_b32 v100, 16, v58
    v_and_b32 v101, 0xffff0000, v58
    v_lshlrev_b32 v102, 16, v59
    v_and_b32 v103, 0xffff0000, v59
    v_pk_fma_f32 v[96:97], v[96:97], s[52:53], s[52:53] op_sel:[0,0,1] op_sel_hi:[1,0,1]
    v_pk_fma_f32 v[98:99], v[98:99], s[52:53], s[52:53] op_sel:[0,0,1] op_sel_hi:[1,0,1]
    v_pk_fma_f32 v[100:101], v[100:101], s[52:53], s[52:53] op_sel:[0,0,1] op_sel_hi:[1,0,1]
    v_pk_fma_f32 v[102:103], v[102:103], s[52:53], s[52:53] op_sel:[0,0,1] op_sel_hi:[1,0,1]
    v_lshlrev_b32 v104, 16, v60
    v_and_b32 v105, 0xffff0000, v60
    v_lshlrev_b32 v106, 16, v61
    v_and_b32 v107, 0xffff0000, v61
    v_lshlrev_b32 v108, 16, v62
    v_and_b32 v109, 0xffff0000, v62
    v_lshlrev_b32 v110, 16, v63
    v_and_b32 v111, 0xffff0000, v63
    v_pk_fma_f32 v[104:105], v[104:105], s[54:55], s[54:55] op_sel:[0,0,1] op_sel_hi:[1,0,1]
    v_pk_fma_f32 v[106:107], v[106:107], s[54:55], s[54:55] op_sel:[0,0,1] op_sel_hi:[1,0,1]
    v_pk_fma_f32 v[108:109], v[108:109], s[54:55], s[54:55] op_sel:[0,0,1] op_sel_hi:[1,0,1]
    v_pk_fma_f32 v[110:111], v[110:111], s[54:55], s[54:55] op_sel:[0,0,1] op_sel_hi:[1,0,1]
    v_lshlrev_b32 v112, 16, v64
    v_and_b32 v113, 0xffff0000, v64
    v_lshlrev_b32 v114, 16, v65
    v_and_b32 v115, 0xffff0000, v65
    v_lshlrev_b32 v116, 16, v66
    v_and_b32 v117, 0xffff0000, v66
    v_lshlrev_b32 v118, 16, v67
    v_and_b32 v119, 0xffff0000, v67
    v_pk_fma_f32 v[112:113], v[112:113], s[56:57], s[56:57] op_sel:[0,0,1] op_sel_hi:[1,0,1]
    v_pk_fma_f32 v[114:115], v[114:115], s[56:57], s[56:57] op_sel:[0,0,1] op_sel_hi:[1,0,1]
    v_pk_fma_f32 v[116:117], v[116:117], s[56:57], s[56:57] op_sel:[0,0,1] op_sel_hi:[1,0,1]
    v_pk_fma_f32 v[118:119], v[118:119], s[56:57], s[56:57] op_sel:[0,0,1] op_sel_hi:[1,0,1]
    v_lshlrev_b32 v120, 16, v68
    v_and_b32 v121, 0xffff0000, v68
    v_lshlrev_b32 v122, 16, v69
    v_and_b32 v123, 0xffff0000, v69
    v_lshlrev_b32 v124, 16, v70
    v_and_b32 v125, 0xffff0000, v70
    v_lshlrev_b32 v126, 16, v71
    v_and_b32 v127, 0xffff0000, v71
    v_pk_fma_f32 v[120:121], v[120:121], s[58:59], s[58:59] op_sel:[0,0,1] op_sel_hi:[1,0,1]
    v_pk_fma_f32 v[122:123], v[122:123], s[58:59], s[58:59] op_sel:[0,0,1] op_sel_hi:[1,0,1]
    v_pk_fma_f32 v[124:125], v[124:125], s[58:59], s[58:59] op_sel:[0,0,1] op_sel_hi:[1,0,1]
    v_pk_fma_f32 v[126:127], v[126:127], s[58:59], s[58:59] op_sel:[0,0,1] op_sel_hi:[1,0,1]
    v_lshlrev_b32 v128, 16, v72
    v_and_b32 v129, 0xffff0000, v72
    v_lshlrev_b32 v130, 16, v73
    v_and_b32 v131, 0xffff0000, v73
    v_lshlrev_b32 v132, 16, v74
    v_and_b32 v133, 0xffff0000, v74
    v_lshlrev_b32 v134, 16, v75
    v_and_b32 v135, 0xffff0000, v75
    v_pk_fma_f32 v[128:129], v[128:129], s[60:61], s[60:61] op_sel:[0,0,1] op_sel_hi:[1,0,1]
    v_pk_fma_f32 v[130:131], v[130:131], s[60:61], s[60:61] op_sel:[0,0,1] op_sel_hi:[1,0,1]
    v_pk_fma_f32 v[132:133], v[132:133], s[60:61], s[60:61] op_sel:[0,0,1] op_sel_hi:[1,0,1]
    v_pk_fma_f32 v[134:135], v[134:135], s[60:61], s[60:61] op_sel:[0,0,1] op_sel_hi:[1,0,1]
    v_lshlrev_b32 v136, 16, v76
    v_and_b32 v137, 0xffff0000, v76
    v_lshlrev_b32 v138, 16, v77
    v_and_b32 v139, 0xffff0000, v77
    v_lshlrev_b32 v140, 16, v78
    v_and_b32 v141, 0xffff0000, v78
    v_lshlrev_b32 v142, 16, v79
    v_and_b32 v143, 0xffff0000, v79
    v_pk_fma_f32 v[136:137], v[136:137], s[62:63], s[62:63] op_sel:[0,0,1] op_sel_hi:[1,0,1]
    v_pk_fma_f32 v[138:139], v[138:139], s[62:63], s[62:63] op_sel:[0,0,1] op_sel_hi:[1,0,1]
    v_pk_fma_f32 v[140:141], v[140:141], s[62:63], s[62:63] op_sel:[0,0,1] op_sel_hi:[1,0,1]
    v_pk_fma_f32 v[142:143], v[142:143], s[62:63], s[62:63] op_sel:[0,0,1] op_sel_hi:[1,0,1]
K2_POLLX:
    s_cmp_lt_u32 s22, 4
    s_cbranch_scc1 K2_CONS
    v_lshrrev_b32 v162, 2, v160
    v_mul_u32_u24 v162, 3072, v162
    v_lshl_add_u32 v162, v163, 4, v162
    s_mul_i32 s27, s24, 49152
    s_lshl_b32 s31, s20, 7
    s_add_u32 s27, s27, s31
    s_lshl_b32 s31, s23, 6
    s_add_u32 s27, s27, s31
    s_mul_i32 s31, s24, 3072
    s_add_u32 s28, s28, s31
    s_add_u32 m0, s28, 0
    s_add_u32 s34, s27, 0
    buffer_load_dwordx4 v162, s[16:19], s34 offen offset:0 lds
    buffer_load_dwordx4 v162, s[16:19], s34 offen offset:1024 lds
    buffer_load_dwordx4 v162, s[16:19], s34 offen offset:2048 lds
    s_add_u32 m0, s28, 6144
    s_add_u32 s34, s27, 98304
    buffer_load_dwordx4 v162, s[16:19], s34 offen offset:0 lds
    buffer_load_dwordx4 v162, s[16:19], s34 offen offset:1024 lds
    buffer_load_dwordx4 v162, s[16:19], s34 offen offset:2048 lds
    s_add_u32 m0, s28, 12288
    s_add_u32 s34, s27, 196608
    buffer_load_dwordx4 v162, s[16:19], s34 offen offset:0 lds
    buffer_load_dwordx4 v162, s[16:19], s34 offen offset:1024 lds
    buffer_load_dwordx4 v162, s[16:19], s34 offen offset:2048 lds
    s_add_u32 m0, s28, 18432
    s_add_u32 s34, s27, 294912
    buffer_load_dwordx4 v162, s[16:19], s34 offen offset:0 lds
    buffer_load_dwordx4 v162, s[16:19], s34 offen offset:1024 lds
    buffer_load_dwordx4 v162, s[16:19], s34 offen offset:2048 lds
    s_barrier
    ds_read_b128 v[152:155], v167 offset:0
    ds_read_b128 v[144:147], v167 offset:2048
    ds_read_b128 v[156:159], v167 offset:16
    ds_read_b128 v[148:151], v167 offset:2064
    s_waitcnt lgkmcnt(0)
    v_pk_fma_f32 v[80:81], v[80:81], v[144:145], v[152:153]
    v_pk_fma_f32 v[82:83], v[82:83], v[146:147], v[154:155]
    v_pk_fma_f32 v[84:85], v[84:85], v[148:149], v[156:157]
    v_pk_fma_f32 v[86:87], v[86:87], v[150:151], v[158:159]
    v_xor_b32 v30, 0, v164
    v_cvt_pk_bf16_f32 v80, v80, v81
    v_cvt_pk_bf16_f32 v81, v82, v83
    v_cvt_pk_bf16_f32 v82, v84, v85
    v_cvt_pk_bf16_f32 v83, v86, v87
    ds_write_b128 v30, v[80:83]
    v_pk_fma_f32 v[88:89], v[88:89], v[144:145], v[152:153]
    v_pk_fma_f32 v[90:91], v[90:91], v[146:147], v[154:155]
    v_pk_fma_f32 v[92:93], v[92:93], v[148:149], v[156:157]
    v_pk_fma_f32 v[94:95], v[94:95], v[150:151], v[158:159]
    v_xor_b32 v31, 16, v164
    v_cvt_pk_bf16_f32 v88, v88, v89
    v_cvt_pk_bf16_f32 v89, v90, v91
    v_cvt_pk_bf16_f32 v90, v92, v93
    v_cvt_pk_bf16_f32 v91, v94, v95
    ds_write_b128 v31, v[88:91]
    v_pk_fma_f32 v[96:97], v[96:97], v[144:145], v[152:153]
    v_pk_fma_f32 v[98:99], v[98:99], v[146:147], v[154:155]
    v_pk_fma_f32 v[100:101], v[100:101], v[148:149], v[156:157]
    v_pk_fma_f32 v[102:103], v[102:103], v[150:151], v[158:159]
    v_xor_b32 v30, 32, v164
    v_cvt_pk_bf16_f32 v96, v96, v97
    v_cvt_pk_bf16_f32 v97, v98, v99
    v_cvt_pk_bf16_f32 v98, v100, v101
    v_cvt_pk_bf16_f32 v99, v102, v103
    ds_write_b128 v30, v[96:99]
    v_pk_fma_f32 v[104:105], v[104:105], v[144:145], v[152:153]
    v_pk_fma_f32 v[106:107], v[106:107], v[146:147], v[154:155]
    v_pk_fma_f32 v[108:109], v[108:109], v[148:149], v[156:157]
    v_pk_fma_f32 v[110:111], v[110:111], v[150:151], v[158:159]
    v_xor_b32 v31, 48, v164
    v_cvt_pk_bf16_f32 v104, v104, v105
    v_cvt_pk_bf16_f32 v105, v106, v107
    v_cvt_pk_bf16_f32 v106, v108, v109
    v_cvt_pk_bf16_f32 v107, v110, v111
    ds_write_b128 v31, v[104:107]
    v_pk_fma_f32 v[112:113], v[112:113], v[144:145], v[152:153]
    v_pk_fma_f32 v[114:115], v[114:115], v[146:147], v[154:155]
    v_pk_fma_f32 v[116:117], v[116:117], v[148:149], v[156:157]
    v_pk_fma_f32 v[118:119], v[118:119], v[150:151], v[158:159]
    v_xor_b32 v30, 64, v164
    v_cvt_pk_bf16_f32 v112, v112, v113
    v_cvt_pk_bf16_f32 v113, v114, v115
    v_cvt_pk_bf16_f32 v114, v116, v117
    v_cvt_pk_bf16_f32 v115, v118, v119
    ds_write_b128 v30, v[112:115]
    v_pk_fma_f32 v[120:121], v[120:121], v[144:145], v[152:153]
    v_pk_fma_f32 v[122:123], v[122:123], v[146:147], v[154:155]
    v_pk_fma_f32 v[124:125], v[124:125], v[148:149], v[156:157]
    v_pk_fma_f32 v[126:127], v[126:127], v[150:151], v[158:159]
    v_xor_b32 v31, 80, v164
    v_cvt_pk_bf16_f32 v120, v120, v121
    v_cvt_pk_bf16_f32 v121, v122, v123
    v_cvt_pk_bf16_f32 v122, v124, v125
    v_cvt_pk_bf16_f32 v123, v126, v127
    ds_write_b128 v31, v[120:123]
    v_pk_fma_f32 v[128:129], v[128:129], v[144:145], v[152:153]
    v_pk_fma_f32 v[130:131], v[130:131], v[146:147], v[154:155]
    v_pk_fma_f32 v[132:133], v[132:133], v[148:149], v[156:157]
    v_pk_fma_f32 v[134:135], v[134:135], v[150:151], v[158:159]
    v_xor_b32 v30, 96, v164
    v_cvt_pk_bf16_f32 v128, v128, v129
    v_cvt_pk_bf16_f32 v129, v130, v131
    v_cvt_pk_bf16_f32 v130, v132, v133
    v_cvt_pk_bf16_f32 v131, v134, v135
    ds_write_b128 v30, v[128:131]
    v_pk_fma_f32 v[136:137], v[136:137], v[144:145], v[152:153]
    v_pk_fma_f32 v[138:139], v[138:139], v[146:147], v[154:155]
    v_pk_fma_f32 v[140:141], v[140:141], v[148:149], v[156:157]
    v_pk_fma_f32 v[142:143], v[142:143], v[150:151], v[158:159]
    v_xor_b32 v31, 112, v164
    v_cvt_pk_bf16_f32 v136, v136, v137
    v_cvt_pk_bf16_f32 v137, v138, v139
    v_cvt_pk_bf16_f32 v138, v140, v141
    v_cvt_pk_bf16_f32 v139, v142, v143
    ds_write_b128 v31, v[136:139]
    s_waitcnt vmcnt(6) lgkmcnt(0)
    s_barrier
    s_add_u32 m0, s28, 24576
    s_add_u32 s34, s27, 393216
    buffer_load_dwordx4 v162, s[16:19], s34 offen offset:0 lds
    buffer_load_dwordx4 v162, s[16:19], s34 offen offset:1024 lds
    buffer_load_dwordx4 v162, s[16:19], s34 offen offset:2048 lds
    s_add_u32 m0, s28, 30720
    s_add_u32 s34, s27, 491520
    buffer_load_dwordx4 v162, s[16:19], s34 offen offset:0 lds
    buffer_load_dwordx4 v162, s[16:19], s34 offen offset:1024 lds
    buffer_load_dwordx4 v162, s[16:19], s34 offen offset:2048 lds
    s_waitcnt vmcnt(9)
    s_barrier
    s_add_u32 m0, s28, 36864
    s_add_u32 s34, s27, 589824
    buffer_load_dwordx4 v162, s[16:19], s34 offen offset:0 lds
    buffer_load_dwordx4 v162, s[16:19], s34 offen offset:1024 lds
    buffer_load_dwordx4 v162, s[16:19], s34 offen offset:2048 lds
    s_add_u32 m0, s28, 43008
    s_add_u32 s34, s27, 688128
    buffer_load_dwordx4 v162, s[16:19], s34 offen offset:0 lds
    buffer_load_dwordx4 v162, s[16:19], s34 offen offset:1024 lds
    buffer_load_dwordx4 v162, s[16:19], s34 offen offset:2048 lds
    s_waitcnt vmcnt(12)
    s_barrier
    s_add_u32 m0, s28, 0
    s_add_u32 s34, s27, 786432
    buffer_load_dwordx4 v162, s[16:19], s34 offen offset:0 lds
    buffer_load_dwordx4 v162, s[16:19], s34 offen offset:1024 lds
    buffer_load_dwordx4 v162, s[16:19], s34 offen offset:2048 lds
    s_add_u32 m0, s28, 6144
    s_add_u32 s34, s27, 884736
    buffer_load_dwordx4 v162, s[16:19], s34 offen offset:0 lds
    buffer_load_dwordx4 v162, s[16:19], s34 offen offset:1024 lds
    buffer_load_dwordx4 v162, s[16:19], s34 offen offset:2048 lds
    s_waitcnt vmcnt(15)
    s_barrier
    s_add_u32 m0, s28, 12288
    s_add_u32 s34, s27, 983040
    buffer_load_dwordx4 v162, s[16:19], s34 offen offset:0 lds
    buffer_load_dwordx4 v162, s[16:19], s34 offen offset:1024 lds
    buffer_load_dwordx4 v162, s[16:19], s34 offen offset:2048 lds
    s_add_u32 m0, s28, 18432
    s_add_u32 s34, s27, 1081344
    buffer_load_dwordx4 v162, s[16:19], s34 offen offset:0 lds
    buffer_load_dwordx4 v162, s[16:19], s34 offen offset:1024 lds
    buffer_load_dwordx4 v162, s[16:19], s34 offen offset:2048 lds
    s_waitcnt vmcnt(18)
    s_barrier
    s_add_u32 m0, s28, 24576
    s_add_u32 s34, s27, 1179648
    buffer_load_dwordx4 v162, s[16:19], s34 offen offset:0 lds
    buffer_load_dwordx4 v162, s[16:19], s34 offen offset:1024 lds
    buffer_load_dwordx4 v162, s[16:19], s34 offen offset:2048 lds
    s_waitcnt vmcnt(18)
    s_barrier
    s_add_u32 m0, s28, 30720
    s_add_u32 s34, s27, 1277952
    buffer_load_dwordx4 v162, s[16:19], s34 offen offset:0 lds
    buffer_load_dwordx4 v162, s[16:19], s34 offen offset:1024 lds
    buffer_load_dwordx4 v162, s[16:19], s34 offen offset:2048 lds
    s_waitcnt vmcnt(18)
    s_barrier
    s_add_u32 m0, s28, 36864
    s_add_u32 s34, s27, 1376256
    buffer_load_dwordx4 v162, s[16:19], s34 offen offset:0 lds
    buffer_load_dwordx4 v162, s[16:19], s34 offen offset:1024 lds
    buffer_load_dwordx4 v162, s[16:19], s34 offen offset:2048 lds
    s_waitcnt vmcnt(18)
    s_barrier
    s_add_u32 m0, s28, 43008
    s_add_u32 s34, s27, 1474560
    buffer_load_dwordx4 v162, s[16:19], s34 offen offset:0 lds
    buffer_load_dwordx4 v162, s[16:19], s34 offen offset:1024 lds
    buffer_load_dwordx4 v162, s[16:19], s34 offen offset:2048 lds
    s_waitcnt vmcnt(18)
    s_barrier
    s_waitcnt vmcnt(15)
    s_barrier
    s_lshl_b32 s53, s2, 2
    s_add_u32 s53, s53, s35
    s_cmp_lt_u32 s53, 464
    s_cselect_b32 s54, 0, 0x40000000
    s_lshl_b32 s53, s53, 10
    s_add_u32 s53, s53, s54
    s_add_u32 s53, s53, 49152
    v_mov_b32 v40, -1
    v_mov_b32 v41, -1
    v_mov_b32 v42, -1
    v_mov_b32 v43, -1
    buffer_store_dwordx4 v[40:43], v161, s[8:11], s53 offen sc1
    s_waitcnt vmcnt(13)
    s_barrier
    s_waitcnt vmcnt(10)
    s_barrier
    s_waitcnt vmcnt(7)
    s_barrier
    s_waitcnt vmcnt(4)
    s_barrier
    s_waitcnt vmcnt(1)
    s_barrier
    s_cmp_lt_u32 s76, 128
    s_cbranch_scc0 K2_LEND
    v_lshlrev_b32 v8, 16, v8
    v_lshlrev_b32 v9, 16, v9
    v_lshlrev_b32 v10, 16, v10
    v_lshlrev_b32 v11, 16, v11
    v_mul_f32 v28, 0xbfb8aa3b, v8
    v_mul_f32 v29, 0xbfb8aa3b, v9
    v_mul_f32 v30, 0xbfb8aa3b, v10
    v_mul_f32 v31, 0xbfb8aa3b, v11
    v_exp_f32 v28, v28
    v_exp_f32 v29, v29
    v_exp_f32 v30, v30
    v_exp_f32 v31, v31
    s_nop 0
    v_add_f32 v28, 1.0, v28
    v_add_f32 v29, 1.0, v29
    v_add_f32 v30, 1.0, v30
    v_add_f32 v31, 1.0, v31
    v_rcp_f32 v28, v28
    v_rcp_f32 v29, v29
    v_rcp_f32 v30, v30
    v_rcp_f32 v31, v31
    s_nop 0
    v_mul_f32 v8, v8, v28
    v_mul_f32 v9, v9, v29
    v_mul_f32 v10, v10, v30
    v_mul_f32 v11, v11, v31
    v_cvt_pk_bf16_f32 v8, v8, v8
    v_cvt_pk_bf16_f32 v9, v9, v9
    v_cvt_pk_bf16_f32 v10, v10, v10
    v_cvt_pk_bf16_f32 v11, v11, v11
    v_and_b32 v8, 0xffff0000, v8
    v_and_b32 v9, 0xffff0000, v9
    v_and_b32 v10, 0xffff0000, v10
    v_and_b32 v11, 0xffff0000, v11
    v_lshlrev_b32 v28, 16, v12
    v_and_b32 v29, 0xffff0000, v12
    v_mul_f32 v32, v28, v8
    v_mul_f32 v33, v29, v8
    v_lshlrev_b32 v28, 16, v13
    v_and_b32 v29, 0xffff0000, v13
    v_mul_f32 v34, v28, v8
    v_mul_f32 v35, v29, v8
    v_lshlrev_b32 v28, 16, v14
    v_and_b32 v29, 0xffff0000, v14
    v_mul_f32 v36, v28, v8
    v_mul_f32 v37, v29, v8
    v_lshlrev_b32 v28, 16, v15
    v_and_b32 v29, 0xffff0000, v15
    v_mul_f32 v38, v28, v8
    v_mul_f32 v39, v29, v8
    v_lshlrev_b32 v28, 16, v16
    v_and_b32 v29, 0xffff0000, v16
    v_fmac_f32 v32, v28, v9
    v_fmac_f32 v33, v29, v9
    v_lshlrev_b32 v28, 16, v17
    v_and_b32 v29, 0xffff0000, v17
    v_fmac_f32 v34, v28, v9
    v_fmac_f32 v35, v29, v9
    v_lshlrev_b32 v28, 16, v18
    v_and_b32 v29, 0xffff0000, v18
    v_fmac_f32 v36, v28, v9
    v_fmac_f32 v37, v29, v9
    v_lshlrev_b32 v28, 16, v19
    v_and_b32 v29, 0xffff0000, v19
    v_fmac_f32 v38, v28, v9
    v_fmac_f32 v39, v29, v9
    v_lshlrev_b32 v28, 16, v20
    v_and_b32 v29, 0xffff0000, v20
    v_fmac_f32 v32, v28, v10
    v_fmac_f32 v33, v29, v10
    v_lshlrev_b32 v28, 16, v21
    v_and_b32 v29, 0xffff0000, v21
    v_fmac_f32 v34, v28, v10
    v_fmac_f32 v35, v29, v10
    v_lshlrev_b32 v28, 16, v22
    v_and_b32 v29, 0xffff0000, v22
    v_fmac_f32 v36, v28, v10
    v_fmac_f32 v37, v29, v10
    v_lshlrev_b32 v28, 16, v23
    v_and_b32 v29, 0xffff0000, v23
    v_fmac_f32 v38, v28, v10
    v_fmac_f32 v39, v29, v10
    v_lshlrev_b32 v28, 16, v24
    v_and_b32 v29, 0xffff0000, v24
    v_fmac_f32 v32, v28, v11
    v_fmac_f32 v33, v29, v11
    v_lshlrev_b32 v28, 16, v25
    v_and_b32 v29, 0xffff0000, v25
    v_fmac_f32 v34, v28, v11
    v_fmac_f32 v35, v29, v11
    v_lshlrev_b32 v28, 16, v26
    v_and_b32 v29, 0xffff0000, v26
    v_fmac_f32 v36, v28, v11
    v_fmac_f32 v37, v29, v11
    v_lshlrev_b32 v28, 16, v27
    v_and_b32 v29, 0xffff0000, v27
    v_fmac_f32 v38, v28, v11
    v_fmac_f32 v39, v29, v11
    s_nop 0
    v_add_f32_dpp v32, v32, v32 row_ror:8 row_mask:0xf bank_mask:0xf
    v_add_f32_dpp v33, v33, v33 row_ror:8 row_mask:0xf bank_mask:0xf
    v_add_f32_dpp v34, v34, v34 row_ror:8 row_mask:0xf bank_mask:0xf
    v_add_f32_dpp v35, v35, v35 row_ror:8 row_mask:0xf bank_mask:0xf
    v_add_f32_dpp v36, v36, v36 row_ror:8 row_mask:0xf bank_mask:0xf
    v_add_f32_dpp v37, v37, v37 row_ror:8 row_mask:0xf bank_mask:0xf
    v_add_f32_dpp v38, v38, v38 row_ror:8 row_mask:0xf bank_mask:0xf
    v_add_f32_dpp v39, v39, v39 row_ror:8 row_mask:0xf bank_mask:0xf
    v_mov_b32 v12, v32
    v_mov_b32 v13, v33
    v_mov_b32 v14, v34
    v_mov_b32 v15, v35
    v_mov_b32 v16, v36
    v_mov_b32 v17, v37
    v_mov_b32 v18, v38
    v_mov_b32 v19, v39
    v_permlane16_swap_b32 v32, v12
    v_permlane16_swap_b32 v33, v13
    v_permlane16_swap_b32 v34, v14
    v_permlane16_swap_b32 v35, v15
    v_permlane16_swap_b32 v36, v16
    v_permlane16_swap_b32 v37, v17
    v_permlane16_swap_b32 v38, v18
    v_permlane16_swap_b32 v39, v19
    v_add_f32 v32, v32, v12
    v_add_f32 v33, v33, v13
    v_add_f32 v34, v34, v14
    v_add_f32 v35, v35, v15
    v_add_f32 v36, v36, v16
    v_add_f32 v37, v37, v17
    v_add_f32 v38, v38, v18
    v_add_f32 v39, v39, v19
    v_mov_b32 v12, v32
    v_mov_b32 v13, v33
    v_mov_b32 v14, v34
    v_mov_b32 v15, v35
    v_mov_b32 v16, v36
    v_mov_b32 v17, v37
    v_mov_b32 v18, v38
    v_mov_b32 v19, v39
    v_permlane32_swap_b32 v32, v12
    v_permlane32_swap_b32 v33, v13
    v_permlane32_swap_b32 v34, v14
    v_permlane32_swap_b32 v35, v15
    v_permlane32_swap_b32 v36, v16
    v_permlane32_swap_b32 v37, v17
    v_permlane32_swap_b32 v38, v18
    v_permlane32_swap_b32 v39, v19
    v_add_f32 v32, v32, v12
    v_add_f32 v33, v33, v13
    v_add_f32 v34, v34, v14
    v_add_f32 v35, v35, v15
    v_add_f32 v36, v36, v16
    v_add_f32 v37, v37, v17
    v_add_f32 v38, v38, v18
    v_add_f32 v39, v39, v19
    s_lshl_b32 s71, s78, 13
    s_lshl_b32 s72, s77, 8
    s_add_u32 s71, s71, s72
    s_add_u32 s71, s71, 651264
    v_lshlrev_b32 v2, 5, v2
    s_mov_b64 exec, 0xff
    buffer_store_dwordx4 v[32:35], v2, s[8:11], s71 offen sc1
    buffer_store_dwordx4 v[36:39], v2, s[8:11], s71 offen offset:16 sc1
    s_mov_b64 exec, -1
K2_LEND:
    s_waitcnt vmcnt(0)
    s_barrier
    s_branch K3_ENTRY
K2_W8:
    s_and_b32 s20, s2, 1
    s_lshl_b32 s20, s20, 2
    s_bfe_u32 s21, s2, 0x20001
    s_add_u32 s20, s20, s21
    s_lshl_b32 s20, s20, 2
    s_bfe_u32 s21, s2, 0x20003
    s_add_u32 s20, s20, s21
    s_lshr_b32 s21, s2, 5
    s_lshl_b32 s25, s21, 18
    s_lshl_b32 s26, s20, 10
    s_add_u32 s25, s25, s26
    s_add_u32 s25, s25, 11534336
    v_mov_b32 v40, -1
    v_mov_b32 v41, -1
    v_mov_b32 v42, -1
    v_mov_b32 v43, -1
    v_mov_b32 v44, 0
    v_mov_b32 v45, 0
    v_mov_b32 v46, 0
    v_mov_b32 v47, 0
    s_cmp_ge_u32 s2, 64
    s_cbranch_scc1 K2_W8B
    s_barrier
K2_W8B:
    s_barrier
    buffer_store_dwordx4 v[40:43], v161, s[8:11], s25 offen sc1
    s_add_u32 s25, s25, 32768
    buffer_store_dwordx4 v[40:43], v161, s[8:11], s25 offen sc1
    s_add_u32 s25, s25, 32768
    buffer_store_dwordx4 v[40:43], v161, s[8:11], s25 offen sc1
    s_add_u32 s25, s25, 32768
    buffer_store_dwordx4 v[40:43], v161, s[8:11], s25 offen sc1
    s_add_u32 s25, s25, 32768
    buffer_store_dwordx4 v[40:43], v161, s[8:11], s25 offen sc1
    s_add_u32 s25, s25, 32768
    buffer_store_dwordx4 v[40:43], v161, s[8:11], s25 offen sc1
    s_add_u32 s25, s25, 32768
    buffer_store_dwordx4 v[40:43], v161, s[8:11], s25 offen sc1
    s_add_u32 s25, s25, 32768
    buffer_store_dwordx4 v[40:43], v161, s[8:11], s25 offen sc1
    v_lshrrev_b32 v1, 1, v160
    v_lshlrev_b32 v1, 13, v1
    v_and_b32 v2, 1, v160
    v_lshl_add_u32 v1, v2, 4, v1
    s_lshl_b32 s25, s21, 10
    s_lshl_b32 s26, s20, 5
    s_add_u32 s25, s25, s26
    s_add_u32 s25, s25, 16384
    s_mov_b64 exec, 0x3f
    buffer_store_dwordx4 v[44:47], v1, s[8:11], s25 offen sc1
    s_mov_b64 exec, -1
    s_getpc_b64 s[48:49]
K2_PC8:
    s_add_u32 s48, s48, K3_ENTRY-K2_PC8
    s_addc_u32 s49, s49, 0
    s_mov_b32 s50, k5_kernel-K3_ENTRY
    s_mov_b32 s51, 0x20000
    v_lshlrev_b32 v1, 7, v160
    s_bfe_u32 s25, s2, 0x20003
    s_lshl_b32 s25, s25, 13
    buffer_load_dword v2, v1, s[48:51], s25 offen
    s_barrier
    s_barrier
    s_barrier
    s_barrier
    s_barrier
    s_barrier
    s_barrier
    s_barrier
    s_barrier
    s_barrier
    s_barrier
    s_barrier
    s_barrier
    s_barrier
    s_barrier
    s_waitcnt vmcnt(0)
    s_barrier
    s_branch K3_PF
K2_CONS:
    v_lshlrev_b32 v12, 4, v0
    v_add_u32 v12, 159744, v12
    v_and_b32 v13, 31, v160
    v_lshrrev_b32 v14, 5, v160
    v_xor_b32 v13, v13, v14
    v_lshlrev_b32 v13, 4, v13
    v_lshl_add_u32 v13, v14, 9, v13
    s_lshl_b32 s36, s24, 15
    v_add_u32 v13, s36, v13
    v_xor_b32 v48, 0, v13
    v_xor_b32 v49, 32, v13
    v_xor_b32 v50, 64, v13
    v_xor_b32 v51, 96, v13
    v_lshlrev_b32 v165, 9, v14
    v_bfe_u32 v13, v160, 2, 2
    v_lshl_add_u32 v165, v13, 6, v165
    v_bfe_u32 v13, v160, 4, 1
    v_lshl_add_u32 v165, v13, 5, v165
    v_lshl_add_u32 v165, v163, 3, v165
    v_add_u32 v165, s28, v165
    s_waitcnt vmcnt(0)
    v_readfirstlane_b32 s65, v31
    s_cmp_lg_u32 s65, 0
    s_cselect_b32 s64, s65, s64
    v_lshlrev_b32 v13, 4, v0
    v_add_u32 v14, 8192, v13
    s_mov_b32 s66, 524288
    s_mov_b32 s71, 528384
    s_mov_b32 s67, 0
    s_cmp_ge_u32 s22, 2
    s_cselect_b32 s72, 1.0, 0
    s_mov_b32 s73, 0x0c040000
K2_TP:
    buffer_load_dwordx4 v[16:19], v13, s[8:11], s66 offen sc1
    buffer_load_dwordx4 v[20:23], v13, s[8:11], s71 offen sc1
    buffer_load_dwordx4 v[24:27], v14, s[8:11], s66 offen sc1
    buffer_load_dwordx4 v[28:31], v14, s[8:11], s71 offen sc1
    s_add_u32 s67, s67, 1
    s_cmp_lg_u32 s65, 0
    s_waitcnt vmcnt(0)
    s_cbranch_scc1 K2_TPX
    v_xor_b32 v15, s64, v19
    v_xor_b32 v11, s64, v23
    v_or_b32 v15, v15, v11
    v_xor_b32 v11, s64, v27
    v_or_b32 v15, v15, v11
    v_xor_b32 v11, s64, v31
    v_or_b32 v15, v15, v11
    v_cmp_ne_u32 vcc, 0, v15
    s_cmp_gt_u32 s67, 0x400000
    s_cbranch_scc1 K2_TPX
    s_cbranch_vccz K2_TPX
    s_branch K2_TP
K2_TPX:
    buffer_load_dword v166, v162, s[16:19], s70 offen
    s_mov_b32 s73, 0x04000c0c
    s_mov_b32 s74, 0x0706000c
    v_perm_b32 v19, v16, v17, s73
    v_perm_b32 v23, v20, v21, s73
    v_perm_b32 v27, v24, v25, s73
    v_perm_b32 v31, v28, v29, s73
    v_perm_b32 v19, v19, v18, s74
    v_perm_b32 v23, v23, v22, s74
    v_perm_b32 v27, v27, v26, s74
    v_perm_b32 v31, v31, v30, s74
    v_pk_add_f32 v[16:17], v[16:17], v[20:21]
    v_pk_add_f32 v[24:25], v[24:25], v[28:29]
    v_pk_add_f32 v[18:19], v[18:19], v[22:23]
    v_pk_add_f32 v[26:27], v[26:27], v[30:31]
    v_pk_add_f32 v[16:17], v[16:17], v[24:25]
    v_pk_add_f32 v[18:19], v[18:19], v[26:27]
    v_cvt_pk_bf16_f32 v16, v16, v16
    v_cvt_pk_bf16_f32 v17, v17, v17
    v_cvt_pk_bf16_f32 v18, v18, v18
    v_cvt_pk_bf16_f32 v19, v19, v19
    v_and_b32 v16, 0xffff0000, v16
    v_and_b32 v17, 0xffff0000, v17
    v_and_b32 v18, 0xffff0000, v18
    v_and_b32 v19, 0xffff0000, v19
    v_add_f32 v16, s72, v16
    v_add_f32 v17, s72, v17
    v_add_f32 v18, s72, v18
    v_add_f32 v19, s72, v19
    v_cvt_pk_bf16_f32 v16, v16, v16
    v_cvt_pk_bf16_f32 v17, v17, v17
    v_cvt_pk_bf16_f32 v18, v18, v18
    v_cvt_pk_bf16_f32 v19, v19, v19
    v_and_b32 v16, 0xffff0000, v16
    v_and_b32 v17, 0xffff0000, v17
    v_and_b32 v18, 0xffff0000, v18
    v_and_b32 v19, 0xffff0000, v19
    ds_write_b128 v12, v[16:19]
    s_waitcnt lgkmcnt(0)
    s_cmp_eq_u32 s79, 0
    s_cbranch_scc1 K2_DA1
    v_mov_b32 v72, 1
    v_mov_b32 v73, 0
    s_mov_b64 exec, 1
    buffer_atomic_add v72, v73, s[44:47], 0 offen sc0 sc1
    s_mov_b64 exec, -1
K2_DA1:
    s_barrier
    ds_read_b128 v[152:155], v167 offset:0
    ds_read_b128 v[144:147], v167 offset:2048
    ds_read_b128 v[156:159], v167 offset:16
    ds_read_b128 v[148:151], v167 offset:2064
    s_lshl_b32 s35, s20, 2
    s_lshl_b32 s36, s23, 1
    s_add_u32 s35, s35, s36
    s_lshl_b32 s35, s35, 16
    s_lshl_b32 s36, s21, 1
    s_add_u32 s36, s36, s24
    s_lshl_b32 s36, s36, 10
    s_add_u32 s35, s35, s36
    s_add_u32 s36, s35, 5242880
    s_add_u32 s37, s35, 5308416
    s_add_u32 s38, s35, 7340032
    s_add_u32 s39, s35, 7405568
    s_add_u32 s40, s35, 9437184
    v_bfe_u32 v52, v160, 4, 1
    v_lshlrev_b32 v52, 16, v52
    v_lshrrev_b32 v53, 5, v160
    v_lshl_add_u32 v52, v53, 8, v52
    v_and_b32 v53, 15, v160
    v_lshl_add_u32 v52, v53, 4, v52
    s_mov_b32 s41, 0x3eb8aa3b
    s_waitcnt lgkmcnt(0)
    v_pk_fma_f32 v[80:81], v[80:81], v[144:145], v[152:153]
    v_pk_fma_f32 v[82:83], v[82:83], v[146:147], v[154:155]
    v_pk_fma_f32 v[84:85], v[84:85], v[148:149], v[156:157]
    v_pk_fma_f32 v[86:87], v[86:87], v[150:151], v[158:159]
    v_xor_b32 v30, 0, v164
    v_cvt_pk_bf16_f32 v80, v80, v81
    v_cvt_pk_bf16_f32 v81, v82, v83
    v_cvt_pk_bf16_f32 v82, v84, v85
    v_cvt_pk_bf16_f32 v83, v86, v87
    ds_write_b128 v30, v[80:83]
    v_pk_fma_f32 v[88:89], v[88:89], v[144:145], v[152:153]
    v_pk_fma_f32 v[90:91], v[90:91], v[146:147], v[154:155]
    v_pk_fma_f32 v[92:93], v[92:93], v[148:149], v[156:157]
    v_pk_fma_f32 v[94:95], v[94:95], v[150:151], v[158:159]
    v_xor_b32 v31, 16, v164
    v_cvt_pk_bf16_f32 v88, v88, v89
    v_cvt_pk_bf16_f32 v89, v90, v91
    v_cvt_pk_bf16_f32 v90, v92, v93
    v_cvt_pk_bf16_f32 v91, v94, v95
    ds_write_b128 v31, v[88:91]
    v_pk_fma_f32 v[96:97], v[96:97], v[144:145], v[152:153]
    v_pk_fma_f32 v[98:99], v[98:99], v[146:147], v[154:155]
    v_pk_fma_f32 v[100:101], v[100:101], v[148:149], v[156:157]
    v_pk_fma_f32 v[102:103], v[102:103], v[150:151], v[158:159]
    v_xor_b32 v30, 32, v164
    v_cvt_pk_bf16_f32 v96, v96, v97
    v_cvt_pk_bf16_f32 v97, v98, v99
    v_cvt_pk_bf16_f32 v98, v100, v101
    v_cvt_pk_bf16_f32 v99, v102, v103
    ds_write_b128 v30, v[96:99]
    v_pk_fma_f32 v[104:105], v[104:105], v[144:145], v[152:153]
    v_pk_fma_f32 v[106:107], v[106:107], v[146:147], v[154:155]
    v_pk_fma_f32 v[108:109], v[108:109], v[148:149], v[156:157]
    v_pk_fma_f32 v[110:111], v[110:111], v[150:151], v[158:159]
    v_xor_b32 v31, 48, v164
    v_cvt_pk_bf16_f32 v104, v104, v105
    v_cvt_pk_bf16_f32 v105, v106, v107
    v_cvt_pk_bf16_f32 v106, v108, v109
    v_cvt_pk_bf16_f32 v107, v110, v111
    ds_write_b128 v31, v[104:107]
    v_pk_fma_f32 v[112:113], v[112:113], v[144:145], v[152:153]
    v_pk_fma_f32 v[114:115], v[114:115], v[146:147], v[154:155]
    v_pk_fma_f32 v[116:117], v[116:117], v[148:149], v[156:157]
    v_pk_fma_f32 v[118:119], v[118:119], v[150:151], v[158:159]
    v_xor_b32 v30, 64, v164
    v_cvt_pk_bf16_f32 v112, v112, v113
    v_cvt_pk_bf16_f32 v113, v114, v115
    v_cvt_pk_bf16_f32 v114, v116, v117
    v_cvt_pk_bf16_f32 v115, v118, v119
    ds_write_b128 v30, v[112:115]
    v_pk_fma_f32 v[120:121], v[120:121], v[144:145], v[152:153]
    v_pk_fma_f32 v[122:123], v[122:123], v[146:147], v[154:155]
    v_pk_fma_f32 v[124:125], v[124:125], v[148:149], v[156:157]
    v_pk_fma_f32 v[126:127], v[126:127], v[150:151], v[158:159]
    v_xor_b32 v31, 80, v164
    v_cvt_pk_bf16_f32 v120, v120, v121
    v_cvt_pk_bf16_f32 v121, v122, v123
    v_cvt_pk_bf16_f32 v122, v124, v125
    v_cvt_pk_bf16_f32 v123, v126, v127
    ds_write_b128 v31, v[120:123]
    v_pk_fma_f32 v[128:129], v[128:129], v[144:145], v[152:153]
    v_pk_fma_f32 v[130:131], v[130:131], v[146:147], v[154:155]
    v_pk_fma_f32 v[132:133], v[132:133], v[148:149], v[156:157]
    v_pk_fma_f32 v[134:135], v[134:135], v[150:151], v[158:159]
    v_xor_b32 v30, 96, v164
    v_cvt_pk_bf16_f32 v128, v128, v129
    v_cvt_pk_bf16_f32 v129, v130, v131
    v_cvt_pk_bf16_f32 v130, v132, v133
    v_cvt_pk_bf16_f32 v131, v134, v135
    ds_write_b128 v30, v[128:131]
    v_pk_fma_f32 v[136:137], v[136:137], v[144:145], v[152:153]
    v_pk_fma_f32 v[138:139], v[138:139], v[146:147], v[154:155]
    v_pk_fma_f32 v[140:141], v[140:141], v[148:149], v[156:157]
    v_pk_fma_f32 v[142:143], v[142:143], v[150:151], v[158:159]
    v_xor_b32 v31, 112, v164
    v_cvt_pk_bf16_f32 v136, v136, v137
    v_cvt_pk_bf16_f32 v137, v138, v139
    v_cvt_pk_bf16_f32 v138, v140, v141
    v_cvt_pk_bf16_f32 v139, v142, v143
    ds_write_b128 v31, v[136:139]
    s_waitcnt lgkmcnt(0)
    s_barrier
    ds_read_b128 v[56:59], v48 offset:0
    ds_read_b64_tr_b16 v[80:81], v165 offset:0
    ds_read_b64_tr_b16 v[82:83], v165 offset:256
    ds_read_b64_tr_b16 v[84:85], v165 offset:1024
    ds_read_b64_tr_b16 v[86:87], v165 offset:1280
    ds_read_b64_tr_b16 v[88:89], v165 offset:2048
    ds_read_b64_tr_b16 v[90:91], v165 offset:2304
    ds_read_b128 v[60:63], v49 offset:1024
    ds_read_b64_tr_b16 v[92:93], v165 offset:3072
    ds_read_b64_tr_b16 v[94:95], v165 offset:3328
    ds_read_b64_tr_b16 v[96:97], v165 offset:4096
    ds_read_b64_tr_b16 v[98:99], v165 offset:4352
    ds_read_b64_tr_b16 v[100:101], v165 offset:5120
    ds_read_b64_tr_b16 v[102:103], v165 offset:5376
    s_waitcnt lgkmcnt(7)
    v_mfma_f32_32x32x16_bf16 v[0:15], v[80:83], v[56:59], 0
    ds_read_b128 v[64:67], v50 offset:2048
    ds_read_b64_tr_b16 v[104:105], v165 offset:6144
    ds_read_b64_tr_b16 v[106:107], v165 offset:6400
    v_mfma_f32_32x32x16_bf16 v[16:31], v[84:87], v[56:59], 0
    ds_read_b64_tr_b16 v[108:109], v165 offset:7168
    ds_read_b64_tr_b16 v[110:111], v165 offset:7424
    ds_read_b64_tr_b16 v[112:113], v165 offset:8192
    v_mfma_f32_32x32x16_bf16 v[32:47], v[56:59], v[88:91], 0
    s_waitcnt lgkmcnt(6)
    ds_read_b64_tr_b16 v[114:115], v165 offset:8448
    ds_read_b128 v[68:71], v51 offset:3072
    ds_read_b64_tr_b16 v[116:117], v165 offset:9216
    v_mfma_f32_32x32x16_bf16 v[0:15], v[92:95], v[60:63], v[0:15]
    ds_read_b64_tr_b16 v[118:119], v165 offset:9472
    ds_read_b64_tr_b16 v[120:121], v165 offset:10240
    ds_read_b64_tr_b16 v[122:123], v165 offset:10496
    v_mfma_f32_32x32x16_bf16 v[16:31], v[96:99], v[60:63], v[16:31]
    ds_read_b64_tr_b16 v[124:125], v165 offset:11264
    ds_read_b64_tr_b16 v[126:127], v165 offset:11520
    v_mfma_f32_32x32x16_bf16 v[32:47], v[60:63], v[100:103], v[32:47]
    s_waitcnt lgkmcnt(0)
    s_barrier
    v_mfma_f32_32x32x16_bf16 v[0:15], v[104:107], v[64:67], v[0:15]
    ds_read_b128 v[56:59], v48 offset:4096
    ds_read_b64_tr_b16 v[80:81], v165 offset:12288
    ds_read_b64_tr_b16 v[82:83], v165 offset:12544
    v_mfma_f32_32x32x16_bf16 v[16:31], v[108:111], v[64:67], v[16:31]
    ds_read_b64_tr_b16 v[84:85], v165 offset:13312
    ds_read_b64_tr_b16 v[86:87], v165 offset:13568
    ds_read_b64_tr_b16 v[88:89], v165 offset:14336
    v_mfma_f32_32x32x16_bf16 v[32:47], v[64:67], v[112:115], v[32:47]
    ds_read_b64_tr_b16 v[90:91], v165 offset:14592
    ds_read_b128 v[60:63], v49 offset:5120
    ds_read_b64_tr_b16 v[92:93], v165 offset:15360
    v_mfma_f32_32x32x16_bf16 v[0:15], v[116:119], v[68:71], v[0:15]
    ds_read_b64_tr_b16 v[94:95], v165 offset:15616
    ds_read_b64_tr_b16 v[96:97], v165 offset:16384
    ds_read_b64_tr_b16 v[98:99], v165 offset:16640
    v_mfma_f32_32x32x16_bf16 v[16:31], v[120:123], v[68:71], v[16:31]
    ds_read_b64_tr_b16 v[100:101], v165 offset:17408
    ds_read_b64_tr_b16 v[102:103], v165 offset:17664
    v_mfma_f32_32x32x16_bf16 v[32:47], v[68:71], v[124:127], v[32:47]
    s_waitcnt lgkmcnt(0)
    s_barrier
    v_mfma_f32_32x32x16_bf16 v[0:15], v[80:83], v[56:59], v[0:15]
    ds_read_b128 v[64:67], v50 offset:6144
    ds_read_b64_tr_b16 v[104:105], v165 offset:18432
    ds_read_b64_tr_b16 v[106:107], v165 offset:18688
    v_mfma_f32_32x32x16_bf16 v[16:31], v[84:87], v[56:59], v[16:31]
    ds_read_b64_tr_b16 v[108:109], v165 offset:19456
    ds_read_b64_tr_b16 v[110:111], v165 offset:19712
    ds_read_b64_tr_b16 v[112:113], v165 offset:20480
    v_mfma_f32_32x32x16_bf16 v[32:47], v[56:59], v[88:91], v[32:47]
    ds_read_b64_tr_b16 v[114:115], v165 offset:20736
    ds_read_b128 v[68:71], v51 offset:7168
    ds_read_b64_tr_b16 v[116:117], v165 offset:21504
    v_mfma_f32_32x32x16_bf16 v[0:15], v[92:95], v[60:63], v[0:15]
    ds_read_b64_tr_b16 v[118:119], v165 offset:21760
    ds_read_b64_tr_b16 v[120:121], v165 offset:22528
    ds_read_b64_tr_b16 v[122:123], v165 offset:22784
    v_mfma_f32_32x32x16_bf16 v[16:31], v[96:99], v[60:63], v[16:31]
    ds_read_b64_tr_b16 v[124:125], v165 offset:23552
    ds_read_b64_tr_b16 v[126:127], v165 offset:23808
    v_mfma_f32_32x32x16_bf16 v[32:47], v[60:63], v[100:103], v[32:47]
    s_waitcnt lgkmcnt(0)
    s_barrier
    v_mfma_f32_32x32x16_bf16 v[0:15], v[104:107], v[64:67], v[0:15]
    ds_read_b128 v[56:59], v48 offset:8192
    ds_read_b64_tr_b16 v[80:81], v165 offset:24576
    ds_read_b64_tr_b16 v[82:83], v165 offset:24832
    v_mfma_f32_32x32x16_bf16 v[16:31], v[108:111], v[64:67], v[16:31]
    ds_read_b64_tr_b16 v[84:85], v165 offset:25600
    ds_read_b64_tr_b16 v[86:87], v165 offset:25856
    ds_read_b64_tr_b16 v[88:89], v165 offset:26624
    v_mfma_f32_32x32x16_bf16 v[32:47], v[64:67], v[112:115], v[32:47]
    ds_read_b64_tr_b16 v[90:91], v165 offset:26880
    ds_read_b128 v[60:63], v49 offset:9216
    ds_read_b64_tr_b16 v[92:93], v165 offset:27648
    v_mfma_f32_32x32x16_bf16 v[0:15], v[116:119], v[68:71], v[0:15]
    ds_read_b64_tr_b16 v[94:95], v165 offset:27904
    ds_read_b64_tr_b16 v[96:97], v165 offset:28672
    ds_read_b64_tr_b16 v[98:99], v165 offset:28928
    v_mfma_f32_32x32x16_bf16 v[16:31], v[120:123], v[68:71], v[16:31]
    ds_read_b64_tr_b16 v[100:101], v165 offset:29696
    ds_read_b64_tr_b16 v[102:103], v165 offset:29952
    v_mfma_f32_32x32x16_bf16 v[32:47], v[68:71], v[124:127], v[32:47]
    s_waitcnt lgkmcnt(0)
    s_barrier
    v_mfma_f32_32x32x16_bf16 v[0:15], v[80:83], v[56:59], v[0:15]
    ds_read_b128 v[64:67], v50 offset:10240
    ds_read_b64_tr_b16 v[104:105], v165 offset:30720
    ds_read_b64_tr_b16 v[106:107], v165 offset:30976
    v_mfma_f32_32x32x16_bf16 v[16:31], v[84:87], v[56:59], v[16:31]
    ds_read_b64_tr_b16 v[108:109], v165 offset:31744
    ds_read_b64_tr_b16 v[110:111], v165 offset:32000
    ds_read_b64_tr_b16 v[112:113], v165 offset:32768
    v_mfma_f32_32x32x16_bf16 v[32:47], v[56:59], v[88:91], v[32:47]
    ds_read_b64_tr_b16 v[114:115], v165 offset:33024
    ds_read_b128 v[68:71], v51 offset:11264
    ds_read_b64_tr_b16 v[116:117], v165 offset:33792
    v_mfma_f32_32x32x16_bf16 v[0:15], v[92:95], v[60:63], v[0:15]
    ds_read_b64_tr_b16 v[118:119], v165 offset:34048
    ds_read_b64_tr_b16 v[120:121], v165 offset:34816
    ds_read_b64_tr_b16 v[122:123], v165 offset:35072
    v_mfma_f32_32x32x16_bf16 v[16:31], v[96:99], v[60:63], v[16:31]
    ds_read_b64_tr_b16 v[124:125], v165 offset:35840
    ds_read_b64_tr_b16 v[126:127], v165 offset:36096
    v_mfma_f32_32x32x16_bf16 v[32:47], v[60:63], v[100:103], v[32:47]
    s_waitcnt lgkmcnt(0)
    s_barrier
    v_mfma_f32_32x32x16_bf16 v[0:15], v[104:107], v[64:67], v[0:15]
    ds_read_b128 v[56:59], v48 offset:12288
    ds_read_b64_tr_b16 v[80:81], v165 offset:36864
    ds_read_b64_tr_b16 v[82:83], v165 offset:37120
    v_mfma_f32_32x32x16_bf16 v[16:31], v[108:111], v[64:67], v[16:31]
    ds_read_b64_tr_b16 v[84:85], v165 offset:37888
    ds_read_b64_tr_b16 v[86:87], v165 offset:38144
    ds_read_b64_tr_b16 v[88:89], v165 offset:38912
    v_mfma_f32_32x32x16_bf16 v[32:47], v[64:67], v[112:115], v[32:47]
    ds_read_b64_tr_b16 v[90:91], v165 offset:39168
    ds_read_b128 v[60:63], v49 offset:13312
    ds_read_b64_tr_b16 v[92:93], v165 offset:39936
    v_mfma_f32_32x32x16_bf16 v[0:15], v[116:119], v[68:71], v[0:15]
    ds_read_b64_tr_b16 v[94:95], v165 offset:40192
    ds_read_b64_tr_b16 v[96:97], v165 offset:40960
    ds_read_b64_tr_b16 v[98:99], v165 offset:41216
    v_mfma_f32_32x32x16_bf16 v[16:31], v[120:123], v[68:71], v[16:31]
    ds_read_b64_tr_b16 v[100:101], v165 offset:41984
    ds_read_b64_tr_b16 v[102:103], v165 offset:42240
    v_mfma_f32_32x32x16_bf16 v[32:47], v[68:71], v[124:127], v[32:47]
    s_waitcnt lgkmcnt(0)
    s_barrier
    v_mfma_f32_32x32x16_bf16 v[0:15], v[80:83], v[56:59], v[0:15]
    ds_read_b128 v[64:67], v50 offset:14336
    ds_read_b64_tr_b16 v[104:105], v165 offset:43008
    ds_read_b64_tr_b16 v[106:107], v165 offset:43264
    v_mfma_f32_32x32x16_bf16 v[16:31], v[84:87], v[56:59], v[16:31]
    ds_read_b64_tr_b16 v[108:109], v165 offset:44032
    ds_read_b64_tr_b16 v[110:111], v165 offset:44288
    ds_read_b64_tr_b16 v[112:113], v165 offset:45056
    v_mfma_f32_32x32x16_bf16 v[32:47], v[56:59], v[88:91], v[32:47]
    ds_read_b64_tr_b16 v[114:115], v165 offset:45312
    ds_read_b128 v[68:71], v51 offset:15360
    ds_read_b64_tr_b16 v[116:117], v165 offset:46080
    v_mfma_f32_32x32x16_bf16 v[0:15], v[92:95], v[60:63], v[0:15]
    ds_read_b64_tr_b16 v[118:119], v165 offset:46336
    ds_read_b64_tr_b16 v[120:121], v165 offset:47104
    ds_read_b64_tr_b16 v[122:123], v165 offset:47360
    v_mfma_f32_32x32x16_bf16 v[16:31], v[96:99], v[60:63], v[16:31]
    ds_read_b64_tr_b16 v[124:125], v165 offset:48128
    ds_read_b64_tr_b16 v[126:127], v165 offset:48384
    v_mfma_f32_32x32x16_bf16 v[32:47], v[60:63], v[100:103], v[32:47]
    s_cmp_eq_u32 s79, 0
    s_cbranch_scc1 K2_DA2
    s_waitcnt vmcnt(0)
    v_readfirstlane_b32 s65, v72
    s_mov_b32 s79, 0
    s_cmp_lg_u32 s65, 63
    s_cbranch_scc1 K2_DA2
    s_mov_b32 s79, 2
    v_mov_b32 v72, s64
    s_mov_b64 exec, 1
    buffer_store_dword v72, v73, s[44:47], 0 offen offset:128 sc1
    s_mov_b64 exec, -1
K2_DA2:
    s_waitcnt lgkmcnt(0)
    s_barrier
    v_mfma_f32_32x32x16_bf16 v[0:15], v[104:107], v[64:67], v[0:15]
    ds_read_b128 v[56:59], v48 offset:16384
    ds_read_b64_tr_b16 v[80:81], v165 offset:0
    ds_read_b64_tr_b16 v[82:83], v165 offset:256
    v_mfma_f32_32x32x16_bf16 v[16:31], v[108:111], v[64:67], v[16:31]
    ds_read_b64_tr_b16 v[84:85], v165 offset:1024
    ds_read_b64_tr_b16 v[86:87], v165 offset:1280
    ds_read_b64_tr_b16 v[88:89], v165 offset:2048
    v_mfma_f32_32x32x16_bf16 v[32:47], v[64:67], v[112:115], v[32:47]
    ds_read_b64_tr_b16 v[90:91], v165 offset:2304
    ds_read_b128 v[60:63], v49 offset:17408
    ds_read_b64_tr_b16 v[92:93], v165 offset:3072
    v_mfma_f32_32x32x16_bf16 v[0:15], v[116:119], v[68:71], v[0:15]
    ds_read_b64_tr_b16 v[94:95], v165 offset:3328
    ds_read_b64_tr_b16 v[96:97], v165 offset:4096
    ds_read_b64_tr_b16 v[98:99], v165 offset:4352
    v_mfma_f32_32x32x16_bf16 v[16:31], v[120:123], v[68:71], v[16:31]
    ds_read_b64_tr_b16 v[100:101], v165 offset:5120
    ds_read_b64_tr_b16 v[102:103], v165 offset:5376
    v_mfma_f32_32x32x16_bf16 v[32:47], v[68:71], v[124:127], v[32:47]
    s_waitcnt lgkmcnt(0)
    s_barrier
    v_mfma_f32_32x32x16_bf16 v[0:15], v[80:83], v[56:59], v[0:15]
    ds_read_b128 v[64:67], v50 offset:18432
    ds_read_b64_tr_b16 v[104:105], v165 offset:6144
    ds_read_b64_tr_b16 v[106:107], v165 offset:6400
    v_mfma_f32_32x32x16_bf16 v[16:31], v[84:87], v[56:59], v[16:31]
    ds_read_b64_tr_b16 v[108:109], v165 offset:7168
    ds_read_b64_tr_b16 v[110:111], v165 offset:7424
    ds_read_b64_tr_b16 v[112:113], v165 offset:8192
    v_mfma_f32_32x32x16_bf16 v[32:47], v[56:59], v[88:91], v[32:47]
    ds_read_b64_tr_b16 v[114:115], v165 offset:8448
    ds_read_b128 v[68:71], v51 offset:19456
    ds_read_b64_tr_b16 v[116:117], v165 offset:9216
    v_mfma_f32_32x32x16_bf16 v[0:15], v[92:95], v[60:63], v[0:15]
    ds_read_b64_tr_b16 v[118:119], v165 offset:9472
    ds_read_b64_tr_b16 v[120:121], v165 offset:10240
    ds_read_b64_tr_b16 v[122:123], v165 offset:10496
    v_mfma_f32_32x32x16_bf16 v[16:31], v[96:99], v[60:63], v[16:31]
    ds_read_b64_tr_b16 v[124:125], v165 offset:11264
    ds_read_b64_tr_b16 v[126:127], v165 offset:11520
    v_mfma_f32_32x32x16_bf16 v[32:47], v[60:63], v[100:103], v[32:47]
    s_waitcnt lgkmcnt(0)
    s_barrier
    v_mfma_f32_32x32x16_bf16 v[0:15], v[104:107], v[64:67], v[0:15]
    ds_read_b128 v[56:59], v48 offset:20480
    ds_read_b64_tr_b16 v[80:81], v165 offset:12288
    ds_read_b64_tr_b16 v[82:83], v165 offset:12544
    v_mfma_f32_32x32x16_bf16 v[16:31], v[108:111], v[64:67], v[16:31]
    ds_read_b64_tr_b16 v[84:85], v165 offset:13312
    ds_read_b64_tr_b16 v[86:87], v165 offset:13568
    ds_read_b64_tr_b16 v[88:89], v165 offset:14336
    v_mfma_f32_32x32x16_bf16 v[32:47], v[64:67], v[112:115], v[32:47]
    ds_read_b64_tr_b16 v[90:91], v165 offset:14592
    ds_read_b128 v[60:63], v49 offset:21504
    ds_read_b64_tr_b16 v[92:93], v165 offset:15360
    v_mfma_f32_32x32x16_bf16 v[0:15], v[116:119], v[68:71], v[0:15]
    ds_read_b64_tr_b16 v[94:95], v165 offset:15616
    ds_read_b64_tr_b16 v[96:97], v165 offset:16384
    ds_read_b64_tr_b16 v[98:99], v165 offset:16640
    v_mfma_f32_32x32x16_bf16 v[16:31], v[120:123], v[68:71], v[16:31]
    ds_read_b64_tr_b16 v[100:101], v165 offset:17408
    ds_read_b64_tr_b16 v[102:103], v165 offset:17664
    v_mfma_f32_32x32x16_bf16 v[32:47], v[68:71], v[124:127], v[32:47]
    s_waitcnt lgkmcnt(0)
    s_barrier
    v_mfma_f32_32x32x16_bf16 v[0:15], v[80:83], v[56:59], v[0:15]
    ds_read_b128 v[64:67], v50 offset:22528
    ds_read_b64_tr_b16 v[104:105], v165 offset:18432
    ds_read_b64_tr_b16 v[106:107], v165 offset:18688
    v_mfma_f32_32x32x16_bf16 v[16:31], v[84:87], v[56:59], v[16:31]
    ds_read_b64_tr_b16 v[108:109], v165 offset:19456
    ds_read_b64_tr_b16 v[110:111], v165 offset:19712
    ds_read_b64_tr_b16 v[112:113], v165 offset:20480
    v_mfma_f32_32x32x16_bf16 v[32:47], v[56:59], v[88:91], v[32:47]
    ds_read_b64_tr_b16 v[114:115], v165 offset:20736
    ds_read_b128 v[68:71], v51 offset:23552
    ds_read_b64_tr_b16 v[116:117], v165 offset:21504
    v_mfma_f32_32x32x16_bf16 v[0:15], v[92:95], v[60:63], v[0:15]
    ds_read_b64_tr_b16 v[118:119], v165 offset:21760
    ds_read_b64_tr_b16 v[120:121], v165 offset:22528
    ds_read_b64_tr_b16 v[122:123], v165 offset:22784
    v_mfma_f32_32x32x16_bf16 v[16:31], v[96:99], v[60:63], v[16:31]
    ds_read_b64_tr_b16 v[124:125], v165 offset:23552
    ds_read_b64_tr_b16 v[126:127], v165 offset:23808
    v_mfma_f32_32x32x16_bf16 v[32:47], v[60:63], v[100:103], v[32:47]
    s_waitcnt lgkmcnt(0)
    s_barrier
    v_mfma_f32_32x32x16_bf16 v[0:15], v[104:107], v[64:67], v[0:15]
    ds_read_b128 v[56:59], v48 offset:24576
    ds_read_b64_tr_b16 v[80:81], v165 offset:24576
    ds_read_b64_tr_b16 v[82:83], v165 offset:24832
    v_mfma_f32_32x32x16_bf16 v[16:31], v[108:111], v[64:67], v[16:31]
    ds_read_b64_tr_b16 v[84:85], v165 offset:25600
    ds_read_b64_tr_b16 v[86:87], v165 offset:25856
    ds_read_b64_tr_b16 v[88:89], v165 offset:26624
    v_mfma_f32_32x32x16_bf16 v[32:47], v[64:67], v[112:115], v[32:47]
    ds_read_b64_tr_b16 v[90:91], v165 offset:26880
    ds_read_b128 v[60:63], v49 offset:25600
    ds_read_b64_tr_b16 v[92:93], v165 offset:27648
    v_mfma_f32_32x32x16_bf16 v[0:15], v[116:119], v[68:71], v[0:15]
    ds_read_b64_tr_b16 v[94:95], v165 offset:27904
    ds_read_b64_tr_b16 v[96:97], v165 offset:28672
    ds_read_b64_tr_b16 v[98:99], v165 offset:28928
    v_mfma_f32_32x32x16_bf16 v[16:31], v[120:123], v[68:71], v[16:31]
    ds_read_b64_tr_b16 v[100:101], v165 offset:29696
    ds_read_b64_tr_b16 v[102:103], v165 offset:29952
    v_mfma_f32_32x32x16_bf16 v[32:47], v[68:71], v[124:127], v[32:47]
    s_waitcnt lgkmcnt(0)
    s_barrier
    v_mfma_f32_32x32x16_bf16 v[0:15], v[80:83], v[56:59], v[0:15]
    ds_read_b128 v[64:67], v50 offset:26624
    ds_read_b64_tr_b16 v[104:105], v165 offset:30720
    ds_read_b64_tr_b16 v[106:107], v165 offset:30976
    v_mfma_f32_32x32x16_bf16 v[16:31], v[84:87], v[56:59], v[16:31]
    ds_read_b64_tr_b16 v[108:109], v165 offset:31744
    ds_read_b64_tr_b16 v[110:111], v165 offset:32000
    ds_read_b64_tr_b16 v[112:113], v165 offset:32768
    v_mfma_f32_32x32x16_bf16 v[32:47], v[56:59], v[88:91], v[32:47]
    ds_read_b64_tr_b16 v[114:115], v165 offset:33024
    ds_read_b128 v[68:71], v51 offset:27648
    ds_read_b64_tr_b16 v[116:117], v165 offset:33792
    v_mfma_f32_32x32x16_bf16 v[0:15], v[92:95], v[60:63], v[0:15]
    ds_read_b64_tr_b16 v[118:119], v165 offset:34048
    ds_read_b64_tr_b16 v[120:121], v165 offset:34816
    ds_read_b64_tr_b16 v[122:123], v165 offset:35072
    v_mfma_f32_32x32x16_bf16 v[16:31], v[96:99], v[60:63], v[16:31]
    ds_read_b64_tr_b16 v[124:125], v165 offset:35840
    ds_read_b64_tr_b16 v[126:127], v165 offset:36096
    v_mfma_f32_32x32x16_bf16 v[32:47], v[60:63], v[100:103], v[32:47]
    s_cmp_eq_u32 s79, 0
    s_cbranch_scc1 K2_DA3
    v_mov_b32 v72, s64
    s_mov_b32 s66, 47104
    s_waitcnt vmcnt(0)
    s_mov_b64 exec, 1
    buffer_store_dword v72, v73, s[8:11], s66 offen sc1
    s_mov_b64 exec, -1
K2_DA3:
    s_waitcnt lgkmcnt(0)
    s_barrier
    v_mfma_f32_32x32x16_bf16 v[0:15], v[104:107], v[64:67], v[0:15]
    ds_read_b128 v[56:59], v48 offset:28672
    ds_read_b64_tr_b16 v[80:81], v165 offset:36864
    ds_read_b64_tr_b16 v[82:83], v165 offset:37120
    v_mfma_f32_32x32x16_bf16 v[16:31], v[108:111], v[64:67], v[16:31]
    ds_read_b64_tr_b16 v[84:85], v165 offset:37888
    ds_read_b64_tr_b16 v[86:87], v165 offset:38144
    ds_read_b64_tr_b16 v[88:89], v165 offset:38912
    v_mfma_f32_32x32x16_bf16 v[32:47], v[64:67], v[112:115], v[32:47]
    ds_read_b64_tr_b16 v[90:91], v165 offset:39168
    ds_read_b128 v[60:63], v49 offset:29696
    ds_read_b64_tr_b16 v[92:93], v165 offset:39936
    v_mfma_f32_32x32x16_bf16 v[0:15], v[116:119], v[68:71], v[0:15]
    ds_read_b64_tr_b16 v[94:95], v165 offset:40192
    ds_read_b64_tr_b16 v[96:97], v165 offset:40960
    ds_read_b64_tr_b16 v[98:99], v165 offset:41216
    v_mfma_f32_32x32x16_bf16 v[16:31], v[120:123], v[68:71], v[16:31]
    ds_read_b64_tr_b16 v[100:101], v165 offset:41984
    ds_read_b64_tr_b16 v[102:103], v165 offset:42240
    v_mfma_f32_32x32x16_bf16 v[32:47], v[68:71], v[124:127], v[32:47]
    s_waitcnt lgkmcnt(0)
    s_barrier
    v_mfma_f32_32x32x16_bf16 v[0:15], v[80:83], v[56:59], v[0:15]
    ds_read_b128 v[64:67], v50 offset:30720
    ds_read_b64_tr_b16 v[104:105], v165 offset:43008
    ds_read_b64_tr_b16 v[106:107], v165 offset:43264
    v_mfma_f32_32x32x16_bf16 v[16:31], v[84:87], v[56:59], v[16:31]
    ds_read_b64_tr_b16 v[108:109], v165 offset:44032
    ds_read_b64_tr_b16 v[110:111], v165 offset:44288
    ds_read_b64_tr_b16 v[112:113], v165 offset:45056
    v_mfma_f32_32x32x16_bf16 v[32:47], v[56:59], v[88:91], v[32:47]
    ds_read_b64_tr_b16 v[114:115], v165 offset:45312
    ds_read_b128 v[68:71], v51 offset:31744
    ds_read_b64_tr_b16 v[116:117], v165 offset:46080
    v_mfma_f32_32x32x16_bf16 v[0:15], v[92:95], v[60:63], v[0:15]
    ds_read_b64_tr_b16 v[118:119], v165 offset:46336
    ds_read_b64_tr_b16 v[120:121], v165 offset:47104
    ds_read_b64_tr_b16 v[122:123], v165 offset:47360
    v_mfma_f32_32x32x16_bf16 v[16:31], v[96:99], v[60:63], v[16:31]
    ds_read_b64_tr_b16 v[124:125], v165 offset:48128
    ds_read_b64_tr_b16 v[126:127], v165 offset:48384
    v_mfma_f32_32x32x16_bf16 v[32:47], v[60:63], v[100:103], v[32:47]
    s_waitcnt lgkmcnt(0)
    v_mfma_f32_32x32x16_bf16 v[0:15], v[104:107], v[64:67], v[0:15]
    v_mfma_f32_32x32x16_bf16 v[0:15], v[116:119], v[68:71], v[0:15]
    v_mfma_f32_32x32x16_bf16 v[16:31], v[108:111], v[64:67], v[16:31]
    v_mfma_f32_32x32x16_bf16 v[16:31], v[120:123], v[68:71], v[16:31]
    v_mfma_f32_32x32x16_bf16 v[32:47], v[64:67], v[112:115], v[32:47]
    v_mfma_f32_32x32x16_bf16 v[32:47], v[68:71], v[124:127], v[32:47]
    s_nop 7
    v_mul_f32 v0, s41, v0
    v_mul_f32 v1, s41, v1
    v_mul_f32 v2, s41, v2
    v_mul_f32 v3, s41, v3
    v_mul_f32 v4, s41, v4
    v_mul_f32 v5, s41, v5
    v_mul_f32 v6, s41, v6
    v_mul_f32 v7, s41, v7
    v_mul_f32 v8, s41, v8
    v_mul_f32 v9, s41, v9
    v_mul_f32 v10, s41, v10
    v_mul_f32 v11, s41, v11
    v_mul_f32 v12, s41, v12
    v_mul_f32 v13, s41, v13
    v_mul_f32 v14, s41, v14
    v_mul_f32 v15, s41, v15
    v_cvt_pk_bf16_f32 v128, v0, v1
    v_cvt_pk_bf16_f32 v129, v2, v3
    v_cvt_pk_bf16_f32 v130, v4, v5
    v_cvt_pk_bf16_f32 v131, v6, v7
    v_cvt_pk_bf16_f32 v132, v8, v9
    v_cvt_pk_bf16_f32 v133, v10, v11
    v_cvt_pk_bf16_f32 v134, v12, v13
    v_cvt_pk_bf16_f32 v135, v14, v15
    buffer_store_dwordx4 v[128:131], v161, s[8:11], s36 offen sc1
    buffer_store_dwordx4 v[132:135], v161, s[8:11], s37 offen sc1
    v_cvt_pk_bf16_f32 v136, v16, v17
    v_cvt_pk_bf16_f32 v137, v18, v19
    v_cvt_pk_bf16_f32 v138, v20, v21
    v_cvt_pk_bf16_f32 v139, v22, v23
    v_cvt_pk_bf16_f32 v140, v24, v25
    v_cvt_pk_bf16_f32 v141, v26, v27
    v_cvt_pk_bf16_f32 v142, v28, v29
    v_cvt_pk_bf16_f32 v143, v30, v31
    buffer_store_dwordx4 v[136:139], v161, s[8:11], s38 offen sc1
    buffer_store_dwordx4 v[140:143], v161, s[8:11], s39 offen sc1
    v_cvt_pk_bf16_f32 v144, v32, v33
    v_cvt_pk_bf16_f32 v145, v34, v35
    v_cvt_pk_bf16_f32 v146, v36, v37
    v_cvt_pk_bf16_f32 v147, v38, v39
    v_cvt_pk_bf16_f32 v148, v40, v41
    v_cvt_pk_bf16_f32 v149, v42, v43
    v_cvt_pk_bf16_f32 v150, v44, v45
    v_cvt_pk_bf16_f32 v151, v46, v47
    buffer_store_dwordx4 v[144:147], v52, s[8:11], s40 offen sc1
    buffer_store_dwordx4 v[148:151], v52, s[8:11], s40 offen offset:512 sc1
    v_mov_b32 v72, s64
    v_mov_b32 v73, 0
    s_lshl_b32 s66, s2, 7
    s_add_u32 s66, s66, 786432
    s_cmp_lg_u32 s22, 0
    s_cbranch_scc1 K2_NT
    ds_write_b32 v73, v72
K2_NT:
    s_waitcnt vmcnt(0) lgkmcnt(0)
    s_barrier
    s_cmp_lg_u32 s22, 0
    s_cbranch_scc1 K3_ENTRY
    s_mov_b64 exec, 1
    buffer_store_dword v72, v73, s[8:11], s66 offen sc1
    s_mov_b64 exec, -1
    s_branch K3_ENTRY
K2_END:
    s_endpgm
K3_ENTRY:
    s_load_dwordx2 s[16:17], s[0:1], 16
    s_mov_b32 s18, 524288
    s_mov_b32 s19, 0x20000
    v_mov_b32 v1, v160
    s_and_b32 s20, s2, 1
    s_lshl_b32 s20, s20, 2
    s_bfe_u32 s21, s2, 0x20001
    s_add_u32 s20, s20, s21
    s_lshl_b32 s20, s20, 2
    s_lshr_b32 s21, s2, 3
    s_and_b32 s21, s21, 3
    s_add_u32 s20, s20, s21
    s_lshr_b32 s21, s2, 5
    s_and_b32 s23, s22, 3
    s_lshr_b32 s24, s22, 2
    v_lshlrev_b32 v2, 4, v1
    v_lshrrev_b32 v3, 5, v1
    v_lshlrev_b32 v3, 8, v3
    v_and_b32 v12, 15, v1
    v_lshl_add_u32 v3, v12, 4, v3
    s_lshl_b32 s25, s20, 16
    s_lshl_b32 s26, s21, 3
    s_lshl_b32 s27, s23, 1
    s_add_u32 s26, s26, s27
    s_add_u32 s27, s26, s24
    s_xor_b32 s28, s27, 1
    s_lshl_b32 s29, s27, 10
    s_add_u32 s29, s29, s25
    s_add_u32 s29, s29, 5242880
    s_lshl_b32 s30, s28, 10
    s_add_u32 s30, s30, s25
    s_add_u32 s30, s30, 5242880
    s_add_u32 s31, s25, 7340032
    s_lshl_b32 s32, s24, 15
    s_add_u32 s32, s32, s31
    s_add_u32 s33, s32, 2097152
    s_mov_b32 s34, 0x0000ffff
    s_mov_b32 s35, 0x0000ffff
    v_and_b32 v13, 27, v1
    v_cmp_eq_u32 vcc, 16, v13
    v_mov_b32 v13, 0x3f803f80
    s_nop 0
    v_cndmask_b32 v132, 0, v13, vcc
    v_mov_b32 v133, v132
    v_mov_b32 v134, v132
    v_mov_b32 v135, v132
    v_mov_b32 v136, v132
    v_mov_b32 v137, v132
    v_mov_b32 v138, v132
    v_mov_b32 v139, v132
    v_mov_b32 v140, v132
    v_mov_b32 v141, v132
    v_mov_b32 v142, v132
    v_mov_b32 v143, v132
    v_mov_b32 v144, v132
    v_mov_b32 v145, v132
    v_mov_b32 v146, v132
    v_mov_b32 v147, v132
    v_mov_b32 v148, v132
    v_mov_b32 v149, v132
    v_mov_b32 v150, v132
    v_mov_b32 v151, v132
    v_mov_b32 v152, v132
    v_mov_b32 v153, v132
    v_mov_b32 v154, v132
    v_mov_b32 v155, v132
    v_cndmask_b32 v156, 0, v13, vcc
    v_mov_b32 v157, v156
    v_mov_b32 v158, v156
    v_mov_b32 v159, v156
    v_mov_b32 v160, v156
    v_mov_b32 v161, v156
    v_mov_b32 v162, v156
    v_mov_b32 v163, v156
    v_mov_b32 v44, 0
    v_mov_b32 v45, 0
    v_mov_b32 v46, 0
    v_mov_b32 v47, 0
    v_mov_b32 v48, 0
    v_mov_b32 v49, 0
    v_mov_b32 v50, 0
    v_mov_b32 v51, 0
    v_mov_b32 v52, 0
    v_mov_b32 v53, 0
    v_mov_b32 v54, 0
    v_mov_b32 v55, 0
    v_mov_b32 v56, 0
    v_mov_b32 v57, 0
    v_mov_b32 v58, 0
    v_mov_b32 v59, 0
    v_mov_b32 v60, 0
    v_mov_b32 v61, 0
    v_mov_b32 v62, 0
    v_mov_b32 v63, 0
    v_mov_b32 v64, 0
    v_mov_b32 v65, 0
    v_mov_b32 v66, 0
    v_mov_b32 v67, 0
    v_mov_b32 v68, 0
    v_mov_b32 v69, 0
    v_mov_b32 v70, 0
    v_mov_b32 v71, 0
    v_mov_b32 v72, 0
    v_mov_b32 v73, 0
    v_mov_b32 v74, 0
    v_mov_b32 v75, 0
    v_mov_b32 v112, 0
    v_mov_b32 v113, 0
    v_mov_b32 v114, 0
    v_mov_b32 v115, 0
    s_lshl_b32 s37, s24, 5
    s_add_u32 s37, s37, 6
    s_lshl_b32 s38, s37, 10
    v_add_u32 v164, s38, v2
    s_mul_i32 s38, s37, 1056
    s_add_u32 s38, s38, 65536
    v_mov_b32 v165, 1040
    v_mov_b32 v166, 1024
    v_cndmask_b32 v165, v165, v166, vcc
    v_and_b32 v166, 16, v1
    v_cmp_eq_u32 vcc, 0, v166
    v_add_u32 v167, 512, v3
    s_nop 0
    v_cndmask_b32 v166, v165, v167, vcc
    v_cndmask_b32 v165, v165, v3, vcc
    v_add_u32 v165, s38, v165
    v_add_u32 v166, s38, v166
    s_barrier
    s_waitcnt lgkmcnt(0)
    buffer_load_dwordx4 v[128:131], v2, s[8:11], s31 offen
    buffer_load_dwordx4 v[4:7], v2, s[8:11], s29 offen
    buffer_load_dwordx4 v[8:11], v2, s[8:11], s30 offen
    buffer_load_dwordx4 v[116:119], v2, s[8:11], s32 offen offset:0
    s_mov_b64 exec, s[34:35]
    buffer_load_dwordx4 v[132:135], v3, s[8:11], s33 offen offset:0
    buffer_load_dwordx4 v[136:139], v3, s[8:11], s33 offen offset:512
    s_mov_b64 exec, -1
    buffer_load_dwordx4 v[120:123], v2, s[8:11], s32 offen offset:1024
    s_mov_b64 exec, s[34:35]
    buffer_load_dwordx4 v[140:143], v3, s[8:11], s33 offen offset:1024
    buffer_load_dwordx4 v[144:147], v3, s[8:11], s33 offen offset:1536
    s_mov_b64 exec, -1
    buffer_load_dwordx4 v[124:127], v2, s[8:11], s32 offen offset:2048
    s_mov_b64 exec, s[34:35]
    buffer_load_dwordx4 v[148:151], v3, s[8:11], s33 offen offset:2048
    buffer_load_dwordx4 v[152:155], v3, s[8:11], s33 offen offset:2560
    s_mov_b64 exec, -1
    s_add_u32 s32, s32, 3072
    s_add_u32 s33, s33, 3072
    s_waitcnt vmcnt(9)
    v_mfma_f32_32x32x16_bf16 v[76:91], v[128:131], v[4:7], 0
    v_mfma_f32_32x32x16_bf16 v[92:107], v[128:131], v[8:11], 0
    s_nop 10
    v_max3_f32 v108, v76, v77, v78
    v_max3_f32 v108, v108, v79, v80
    v_max3_f32 v108, v108, v81, v82
    v_max3_f32 v108, v108, v83, v84
    v_max3_f32 v108, v108, v85, v86
    v_max3_f32 v108, v108, v87, v88
    v_max3_f32 v108, v108, v89, v90
    v_max_f32 v108, v108, v91
    v_max3_f32 v109, v92, v93, v94
    v_max3_f32 v109, v109, v95, v96
    v_max3_f32 v109, v109, v97, v98
    v_max3_f32 v109, v109, v99, v100
    v_max3_f32 v109, v109, v101, v102
    v_max3_f32 v109, v109, v103, v104
    v_max3_f32 v109, v109, v105, v106
    v_max_f32 v109, v109, v107
    v_mov_b32 v110, v108
    v_mov_b32 v111, v109
    s_nop 1
    v_permlane32_swap_b32 v108, v110
    v_permlane32_swap_b32 v109, v111
    v_max_f32 v108, v108, v110
    v_max_f32 v109, v109, v111
    v_xor_b32 v12, 0x80000000, v108
    v_xor_b32 v13, 0x80000000, v108
    v_xor_b32 v14, 0x80000000, v108
    v_xor_b32 v15, 0x80000000, v108
    v_xor_b32 v16, 0x80000000, v108
    v_xor_b32 v17, 0x80000000, v108
    v_xor_b32 v18, 0x80000000, v108
    v_xor_b32 v19, 0x80000000, v108
    v_xor_b32 v20, 0x80000000, v108
    v_xor_b32 v21, 0x80000000, v108
    v_xor_b32 v22, 0x80000000, v108
    v_xor_b32 v23, 0x80000000, v108
    v_xor_b32 v24, 0x80000000, v108
    v_xor_b32 v25, 0x80000000, v108
    v_xor_b32 v26, 0x80000000, v108
    v_xor_b32 v27, 0x80000000, v108
    s_waitcnt vmcnt(6)
    v_xor_b32 v28, 0x80000000, v109
    v_xor_b32 v29, 0x80000000, v109
    v_mfma_f32_32x32x16_bf16 v[76:91], v[116:119], v[4:7], v[12:27]
    v_xor_b32 v30, 0x80000000, v109
    v_xor_b32 v31, 0x80000000, v109
    v_xor_b32 v32, 0x80000000, v109
    v_xor_b32 v33, 0x80000000, v109
    v_xor_b32 v34, 0x80000000, v109
    v_xor_b32 v35, 0x80000000, v109
    v_xor_b32 v36, 0x80000000, v109
    v_xor_b32 v37, 0x80000000, v109
    v_xor_b32 v38, 0x80000000, v109
    v_xor_b32 v39, 0x80000000, v109
    v_xor_b32 v40, 0x80000000, v109
    v_xor_b32 v41, 0x80000000, v109
    v_xor_b32 v42, 0x80000000, v109
    v_xor_b32 v43, 0x80000000, v109
    s_mov_b32 s36, 7
    s_nop 1
    v_mfma_f32_32x32x16_bf16 v[92:107], v[116:119], v[8:11], v[28:43]
    v_exp_f32 v76, v76
    v_exp_f32 v77, v77
    v_exp_f32 v78, v78
    v_exp_f32 v79, v79
    v_cvt_pk_bf16_f32 v108, v76, v77
    v_exp_f32 v80, v80
    v_exp_f32 v81, v81
    v_cvt_pk_bf16_f32 v109, v78, v79
    v_mfma_f32_32x32x16_bf16 v[60:75], v[160:163], v[112:115], v[60:75]
    v_exp_f32 v82, v82
    v_exp_f32 v83, v83
    v_cvt_pk_bf16_f32 v110, v80, v81
    buffer_load_dwordx4 v[128:131], v2, s[8:11], s32 offen offset:0
    s_mov_b64 exec, s[34:35]
    buffer_load_dwordx4 v[156:159], v3, s[8:11], s33 offen offset:0
    buffer_load_dwordx4 v[160:163], v3, s[8:11], s33 offen offset:512
    s_mov_b64 exec, -1
    v_exp_f32 v84, v84
    v_cvt_pk_bf16_f32 v111, v82, v83
    v_exp_f32 v85, v85
    v_exp_f32 v86, v86
    v_exp_f32 v87, v87
    v_mfma_f32_32x32x16_bf16 v[44:59], v[132:135], v[108:111], v[44:59]
    v_cvt_pk_bf16_f32 v112, v84, v85
    v_exp_f32 v88, v88
    v_exp_f32 v89, v89
    v_cvt_pk_bf16_f32 v113, v86, v87
    v_exp_f32 v90, v90
    v_exp_f32 v91, v91
    v_cvt_pk_bf16_f32 v114, v88, v89
    v_cvt_pk_bf16_f32 v115, v90, v91
    s_waitcnt vmcnt(6)
    v_mfma_f32_32x32x16_bf16 v[76:91], v[120:123], v[4:7], v[12:27]
    v_exp_f32 v92, v92
    v_exp_f32 v93, v93
    v_exp_f32 v94, v94
    v_exp_f32 v95, v95
    v_cvt_pk_bf16_f32 v108, v92, v93
    v_exp_f32 v96, v96
    v_exp_f32 v97, v97
    v_cvt_pk_bf16_f32 v109, v94, v95
    v_mfma_f32_32x32x16_bf16 v[44:59], v[136:139], v[112:115], v[44:59]
    v_exp_f32 v98, v98
    v_exp_f32 v99, v99
    v_cvt_pk_bf16_f32 v110, v96, v97
    v_exp_f32 v100, v100
    v_cvt_pk_bf16_f32 v111, v98, v99
    v_exp_f32 v101, v101
    v_exp_f32 v102, v102
    v_exp_f32 v103, v103
    v_mfma_f32_32x32x16_bf16 v[60:75], v[132:135], v[108:111], v[60:75]
    v_cvt_pk_bf16_f32 v112, v100, v101
    v_exp_f32 v104, v104
    v_exp_f32 v105, v105
    v_cvt_pk_bf16_f32 v113, v102, v103
    v_exp_f32 v106, v106
    v_exp_f32 v107, v107
    v_cvt_pk_bf16_f32 v114, v104, v105
    v_cvt_pk_bf16_f32 v115, v106, v107
    v_mfma_f32_32x32x16_bf16 v[92:107], v[120:123], v[8:11], v[28:43]
    v_exp_f32 v76, v76
    v_exp_f32 v77, v77
    v_exp_f32 v78, v78
    v_exp_f32 v79, v79
    v_cvt_pk_bf16_f32 v108, v76, v77
    v_exp_f32 v80, v80
    v_exp_f32 v81, v81
    v_cvt_pk_bf16_f32 v109, v78, v79
    v_mfma_f32_32x32x16_bf16 v[60:75], v[136:139], v[112:115], v[60:75]
    v_exp_f32 v82, v82
    v_exp_f32 v83, v83
    v_cvt_pk_bf16_f32 v110, v80, v81
    buffer_load_dwordx4 v[116:119], v2, s[8:11], s32 offen offset:1024
    s_mov_b64 exec, s[34:35]
    buffer_load_dwordx4 v[132:135], v3, s[8:11], s33 offen offset:1024
    buffer_load_dwordx4 v[136:139], v3, s[8:11], s33 offen offset:1536
    s_mov_b64 exec, -1
    v_exp_f32 v84, v84
    v_cvt_pk_bf16_f32 v111, v82, v83
    v_exp_f32 v85, v85
    v_exp_f32 v86, v86
    v_exp_f32 v87, v87
    v_mfma_f32_32x32x16_bf16 v[44:59], v[140:143], v[108:111], v[44:59]
    v_cvt_pk_bf16_f32 v112, v84, v85
    v_exp_f32 v88, v88
    v_exp_f32 v89, v89
    v_cvt_pk_bf16_f32 v113, v86, v87
    v_exp_f32 v90, v90
    v_exp_f32 v91, v91
    v_cvt_pk_bf16_f32 v114, v88, v89
    v_cvt_pk_bf16_f32 v115, v90, v91
    s_waitcnt vmcnt(6)
    v_mfma_f32_32x32x16_bf16 v[76:91], v[124:127], v[4:7], v[12:27]
    v_exp_f32 v92, v92
    v_exp_f32 v93, v93
    v_exp_f32 v94, v94
    v_exp_f32 v95, v95
    v_cvt_pk_bf16_f32 v108, v92, v93
    v_exp_f32 v96, v96
    v_exp_f32 v97, v97
    v_cvt_pk_bf16_f32 v109, v94, v95
    v_mfma_f32_32x32x16_bf16 v[44:59], v[144:147], v[112:115], v[44:59]
    v_exp_f32 v98, v98
    v_exp_f32 v99, v99
    v_cvt_pk_bf16_f32 v110, v96, v97
    v_exp_f32 v100, v100
    v_cvt_pk_bf16_f32 v111, v98, v99
    v_exp_f32 v101, v101
    v_exp_f32 v102, v102
    v_exp_f32 v103, v103
    v_mfma_f32_32x32x16_bf16 v[60:75], v[140:143], v[108:111], v[60:75]
    v_cvt_pk_bf16_f32 v112, v100, v101
    v_exp_f32 v104, v104
    v_exp_f32 v105, v105
    v_cvt_pk_bf16_f32 v113, v102, v103
    v_exp_f32 v106, v106
    v_exp_f32 v107, v107
    v_cvt_pk_bf16_f32 v114, v104, v105
    v_cvt_pk_bf16_f32 v115, v106, v107
    v_mfma_f32_32x32x16_bf16 v[92:107], v[124:127], v[8:11], v[28:43]
    v_exp_f32 v76, v76
    v_exp_f32 v77, v77
    v_exp_f32 v78, v78
    v_exp_f32 v79, v79
    v_cvt_pk_bf16_f32 v108, v76, v77
    v_exp_f32 v80, v80
    v_exp_f32 v81, v81
    v_cvt_pk_bf16_f32 v109, v78, v79
    v_mfma_f32_32x32x16_bf16 v[60:75], v[144:147], v[112:115], v[60:75]
    v_exp_f32 v82, v82
    v_exp_f32 v83, v83
    v_cvt_pk_bf16_f32 v110, v80, v81
    buffer_load_dwordx4 v[120:123], v2, s[8:11], s32 offen offset:2048
    s_mov_b64 exec, s[34:35]
    buffer_load_dwordx4 v[140:143], v3, s[8:11], s33 offen offset:2048
    buffer_load_dwordx4 v[144:147], v3, s[8:11], s33 offen offset:2560
    s_mov_b64 exec, -1
    v_exp_f32 v84, v84
    v_cvt_pk_bf16_f32 v111, v82, v83
    v_exp_f32 v85, v85
    v_exp_f32 v86, v86
    v_exp_f32 v87, v87
    v_mfma_f32_32x32x16_bf16 v[44:59], v[148:151], v[108:111], v[44:59]
    v_cvt_pk_bf16_f32 v112, v84, v85
    v_exp_f32 v88, v88
    v_exp_f32 v89, v89
    v_cvt_pk_bf16_f32 v113, v86, v87
    v_exp_f32 v90, v90
    v_exp_f32 v91, v91
    v_cvt_pk_bf16_f32 v114, v88, v89
    v_cvt_pk_bf16_f32 v115, v90, v91
    s_waitcnt vmcnt(6)
    v_mfma_f32_32x32x16_bf16 v[76:91], v[128:131], v[4:7], v[12:27]
    v_exp_f32 v92, v92
    v_exp_f32 v93, v93
    v_exp_f32 v94, v94
    v_exp_f32 v95, v95
    v_cvt_pk_bf16_f32 v108, v92, v93
    v_exp_f32 v96, v96
    v_exp_f32 v97, v97
    v_cvt_pk_bf16_f32 v109, v94, v95
    v_mfma_f32_32x32x16_bf16 v[44:59], v[152:155], v[112:115], v[44:59]
    v_exp_f32 v98, v98
    v_exp_f32 v99, v99
    v_cvt_pk_bf16_f32 v110, v96, v97
    v_exp_f32 v100, v100
    v_cvt_pk_bf16_f32 v111, v98, v99
    v_exp_f32 v101, v101
    v_exp_f32 v102, v102
    v_exp_f32 v103, v103
    v_mfma_f32_32x32x16_bf16 v[60:75], v[148:151], v[108:111], v[60:75]
    v_cvt_pk_bf16_f32 v112, v100, v101
    v_exp_f32 v104, v104
    v_exp_f32 v105, v105
    v_cvt_pk_bf16_f32 v113, v102, v103
    v_exp_f32 v106, v106
    v_exp_f32 v107, v107
    v_cvt_pk_bf16_f32 v114, v104, v105
    v_cvt_pk_bf16_f32 v115, v106, v107
    v_mfma_f32_32x32x16_bf16 v[92:107], v[128:131], v[8:11], v[28:43]
    v_exp_f32 v76, v76
    v_exp_f32 v77, v77
    v_exp_f32 v78, v78
    v_exp_f32 v79, v79
    v_cvt_pk_bf16_f32 v108, v76, v77
    v_exp_f32 v80, v80
    v_exp_f32 v81, v81
    v_cvt_pk_bf16_f32 v109, v78, v79
    v_mfma_f32_32x32x16_bf16 v[60:75], v[152:155], v[112:115], v[60:75]
    v_exp_f32 v82, v82
    v_exp_f32 v83, v83
    v_cvt_pk_bf16_f32 v110, v80, v81
    v_exp_f32 v84, v84
    v_cvt_pk_bf16_f32 v111, v82, v83
    v_exp_f32 v85, v85
    v_exp_f32 v86, v86
    v_exp_f32 v87, v87
    v_mfma_f32_32x32x16_bf16 v[44:59], v[156:159], v[108:111], v[44:59]
    v_cvt_pk_bf16_f32 v112, v84, v85
    v_exp_f32 v88, v88
    v_exp_f32 v89, v89
    v_cvt_pk_bf16_f32 v113, v86, v87
    v_exp_f32 v90, v90
    v_exp_f32 v91, v91
    v_cvt_pk_bf16_f32 v114, v88, v89
    v_cvt_pk_bf16_f32 v115, v90, v91
    s_waitcnt vmcnt(3)
    v_mfma_f32_32x32x16_bf16 v[76:91], v[116:119], v[4:7], v[12:27]
    v_exp_f32 v92, v92
    v_exp_f32 v93, v93
    v_exp_f32 v94, v94
    v_exp_f32 v95, v95
    v_cvt_pk_bf16_f32 v108, v92, v93
    v_exp_f32 v96, v96
    v_exp_f32 v97, v97
    v_cvt_pk_bf16_f32 v109, v94, v95
    v_mfma_f32_32x32x16_bf16 v[44:59], v[160:163], v[112:115], v[44:59]
    v_exp_f32 v98, v98
    v_exp_f32 v99, v99
    v_cvt_pk_bf16_f32 v110, v96, v97
    v_exp_f32 v100, v100
    v_cvt_pk_bf16_f32 v111, v98, v99
    v_exp_f32 v101, v101
    v_exp_f32 v102, v102
    v_exp_f32 v103, v103
    v_mfma_f32_32x32x16_bf16 v[60:75], v[156:159], v[108:111], v[60:75]
    v_cvt_pk_bf16_f32 v112, v100, v101
    v_exp_f32 v104, v104
    v_exp_f32 v105, v105
    v_cvt_pk_bf16_f32 v113, v102, v103
    v_exp_f32 v106, v106
    v_exp_f32 v107, v107
    v_cvt_pk_bf16_f32 v114, v104, v105
    v_cvt_pk_bf16_f32 v115, v106, v107
    s_waitcnt vmcnt(0)
    s_barrier
    v_mfma_f32_32x32x16_bf16 v[92:107], v[116:119], v[8:11], v[28:43]
    v_exp_f32 v76, v76
    v_exp_f32 v77, v77
    v_exp_f32 v78, v78
    v_exp_f32 v79, v79
    v_cvt_pk_bf16_f32 v108, v76, v77
    v_exp_f32 v80, v80
    v_exp_f32 v81, v81
    v_cvt_pk_bf16_f32 v109, v78, v79
    v_mfma_f32_32x32x16_bf16 v[60:75], v[160:163], v[112:115], v[60:75]
    v_exp_f32 v82, v82
    v_exp_f32 v83, v83
    v_cvt_pk_bf16_f32 v110, v80, v81
    ds_read_b128 v[124:127], v164 offset:0
    ds_read_b128 v[148:151], v165 offset:0
    ds_read_b128 v[152:155], v166 offset:0
    v_exp_f32 v84, v84
    v_cvt_pk_bf16_f32 v111, v82, v83
    v_exp_f32 v85, v85
    v_exp_f32 v86, v86
    v_exp_f32 v87, v87
    v_mfma_f32_32x32x16_bf16 v[44:59], v[132:135], v[108:111], v[44:59]
    v_cvt_pk_bf16_f32 v112, v84, v85
    v_exp_f32 v88, v88
    v_exp_f32 v89, v89
    v_cvt_pk_bf16_f32 v113, v86, v87
    v_exp_f32 v90, v90
    v_exp_f32 v91, v91
    v_cvt_pk_bf16_f32 v114, v88, v89
    v_cvt_pk_bf16_f32 v115, v90, v91
    s_waitcnt lgkmcnt(3)
    v_mfma_f32_32x32x16_bf16 v[76:91], v[120:123], v[4:7], v[12:27]
    v_exp_f32 v92, v92
    v_exp_f32 v93, v93
    v_exp_f32 v94, v94
    v_exp_f32 v95, v95
    v_cvt_pk_bf16_f32 v108, v92, v93
    v_exp_f32 v96, v96
    v_exp_f32 v97, v97
    v_cvt_pk_bf16_f32 v109, v94, v95
    v_mfma_f32_32x32x16_bf16 v[44:59], v[136:139], v[112:115], v[44:59]
    v_exp_f32 v98, v98
    v_exp_f32 v99, v99
    v_cvt_pk_bf16_f32 v110, v96, v97
    v_exp_f32 v100, v100
    v_cvt_pk_bf16_f32 v111, v98, v99
    v_exp_f32 v101, v101
    v_exp_f32 v102, v102
    v_exp_f32 v103, v103
    v_mfma_f32_32x32x16_bf16 v[60:75], v[132:135], v[108:111], v[60:75]
    v_cvt_pk_bf16_f32 v112, v100, v101
    v_exp_f32 v104, v104
    v_exp_f32 v105, v105
    v_cvt_pk_bf16_f32 v113, v102, v103
    v_exp_f32 v106, v106
    v_exp_f32 v107, v107
    v_cvt_pk_bf16_f32 v114, v104, v105
    v_cvt_pk_bf16_f32 v115, v106, v107
    v_mfma_f32_32x32x16_bf16 v[92:107], v[120:123], v[8:11], v[28:43]
    v_exp_f32 v76, v76
    v_exp_f32 v77, v77
    v_exp_f32 v78, v78
    v_exp_f32 v79, v79
    v_cvt_pk_bf16_f32 v108, v76, v77
    v_exp_f32 v80, v80
    v_exp_f32 v81, v81
    v_cvt_pk_bf16_f32 v109, v78, v79
    v_mfma_f32_32x32x16_bf16 v[60:75], v[136:139], v[112:115], v[60:75]
    v_exp_f32 v82, v82
    v_exp_f32 v83, v83
    v_cvt_pk_bf16_f32 v110, v80, v81
    ds_read_b128 v[128:131], v164 offset:1024
    ds_read_b128 v[156:159], v165 offset:1056
    ds_read_b128 v[160:163], v166 offset:1056
    v_exp_f32 v84, v84
    v_cvt_pk_bf16_f32 v111, v82, v83
    v_exp_f32 v85, v85
    v_exp_f32 v86, v86
    v_exp_f32 v87, v87
    v_mfma_f32_32x32x16_bf16 v[44:59], v[140:143], v[108:111], v[44:59]
    v_cvt_pk_bf16_f32 v112, v84, v85
    v_exp_f32 v88, v88
    v_exp_f32 v89, v89
    v_cvt_pk_bf16_f32 v113, v86, v87
    v_exp_f32 v90, v90
    v_exp_f32 v91, v91
    v_cvt_pk_bf16_f32 v114, v88, v89
    v_cvt_pk_bf16_f32 v115, v90, v91
    s_waitcnt lgkmcnt(3)
    v_mfma_f32_32x32x16_bf16 v[76:91], v[124:127], v[4:7], v[12:27]
    v_exp_f32 v92, v92
    v_exp_f32 v93, v93
    v_exp_f32 v94, v94
    v_exp_f32 v95, v95
    v_cvt_pk_bf16_f32 v108, v92, v93
    v_exp_f32 v96, v96
    v_exp_f32 v97, v97
    v_cvt_pk_bf16_f32 v109, v94, v95
    v_mfma_f32_32x32x16_bf16 v[44:59], v[144:147], v[112:115], v[44:59]
    v_exp_f32 v98, v98
    v_exp_f32 v99, v99
    v_cvt_pk_bf16_f32 v110, v96, v97
    v_exp_f32 v100, v100
    v_cvt_pk_bf16_f32 v111, v98, v99
    v_exp_f32 v101, v101
    v_exp_f32 v102, v102
    v_exp_f32 v103, v103
    v_mfma_f32_32x32x16_bf16 v[60:75], v[140:143], v[108:111], v[60:75]
    v_cvt_pk_bf16_f32 v112, v100, v101
    v_exp_f32 v104, v104
    v_exp_f32 v105, v105
    v_cvt_pk_bf16_f32 v113, v102, v103
    v_exp_f32 v106, v106
    v_exp_f32 v107, v107
    v_cvt_pk_bf16_f32 v114, v104, v105
    v_cvt_pk_bf16_f32 v115, v106, v107
    v_mfma_f32_32x32x16_bf16 v[92:107], v[124:127], v[8:11], v[28:43]
    v_exp_f32 v76, v76
    v_exp_f32 v77, v77
    v_exp_f32 v78, v78
    v_exp_f32 v79, v79
    v_cvt_pk_bf16_f32 v108, v76, v77
    v_exp_f32 v80, v80
    v_exp_f32 v81, v81
    v_cvt_pk_bf16_f32 v109, v78, v79
    v_mfma_f32_32x32x16_bf16 v[60:75], v[144:147], v[112:115], v[60:75]
    v_exp_f32 v82, v82
    v_exp_f32 v83, v83
    v_cvt_pk_bf16_f32 v110, v80, v81
    ds_read_b128 v[116:119], v164 offset:2048
    ds_read_b128 v[132:135], v165 offset:2112
    ds_read_b128 v[136:139], v166 offset:2112
    v_exp_f32 v84, v84
    v_cvt_pk_bf16_f32 v111, v82, v83
    v_exp_f32 v85, v85
    v_exp_f32 v86, v86
    v_exp_f32 v87, v87
    v_mfma_f32_32x32x16_bf16 v[44:59], v[148:151], v[108:111], v[44:59]
    v_cvt_pk_bf16_f32 v112, v84, v85
    v_exp_f32 v88, v88
    v_exp_f32 v89, v89
    v_cvt_pk_bf16_f32 v113, v86, v87
    v_exp_f32 v90, v90
    v_exp_f32 v91, v91
    v_cvt_pk_bf16_f32 v114, v88, v89
    v_cvt_pk_bf16_f32 v115, v90, v91
    s_waitcnt lgkmcnt(3)
    v_mfma_f32_32x32x16_bf16 v[76:91], v[128:131], v[4:7], v[12:27]
    v_exp_f32 v92, v92
    v_exp_f32 v93, v93
    v_exp_f32 v94, v94
    v_exp_f32 v95, v95
    v_cvt_pk_bf16_f32 v108, v92, v93
    v_exp_f32 v96, v96
    v_exp_f32 v97, v97
    v_cvt_pk_bf16_f32 v109, v94, v95
    v_mfma_f32_32x32x16_bf16 v[44:59], v[152:155], v[112:115], v[44:59]
    v_exp_f32 v98, v98
    v_exp_f32 v99, v99
    v_cvt_pk_bf16_f32 v110, v96, v97
    v_exp_f32 v100, v100
    v_cvt_pk_bf16_f32 v111, v98, v99
    v_exp_f32 v101, v101
    v_exp_f32 v102, v102
    v_exp_f32 v103, v103
    v_mfma_f32_32x32x16_bf16 v[60:75], v[148:151], v[108:111], v[60:75]
    v_cvt_pk_bf16_f32 v112, v100, v101
    v_exp_f32 v104, v104
    v_exp_f32 v105, v105
    v_cvt_pk_bf16_f32 v113, v102, v103
    v_exp_f32 v106, v106
    v_exp_f32 v107, v107
    v_cvt_pk_bf16_f32 v114, v104, v105
    v_cvt_pk_bf16_f32 v115, v106, v107
    v_mfma_f32_32x32x16_bf16 v[92:107], v[128:131], v[8:11], v[28:43]
    v_exp_f32 v76, v76
    v_exp_f32 v77, v77
    v_exp_f32 v78, v78
    v_exp_f32 v79, v79
    v_cvt_pk_bf16_f32 v108, v76, v77
    v_exp_f32 v80, v80
    v_exp_f32 v81, v81
    v_cvt_pk_bf16_f32 v109, v78, v79
    v_mfma_f32_32x32x16_bf16 v[60:75], v[152:155], v[112:115], v[60:75]
    v_exp_f32 v82, v82
    v_exp_f32 v83, v83
    v_cvt_pk_bf16_f32 v110, v80, v81
    ds_read_b128 v[120:123], v164 offset:3072
    ds_read_b128 v[140:143], v165 offset:3168
    ds_read_b128 v[144:147], v166 offset:3168
    v_exp_f32 v84, v84
    v_cvt_pk_bf16_f32 v111, v82, v83
    v_exp_f32 v85, v85
    v_exp_f32 v86, v86
    v_exp_f32 v87, v87
    v_mfma_f32_32x32x16_bf16 v[44:59], v[156:159], v[108:111], v[44:59]
    v_cvt_pk_bf16_f32 v112, v84, v85
    v_exp_f32 v88, v88
    v_exp_f32 v89, v89
    v_cvt_pk_bf16_f32 v113, v86, v87
    v_exp_f32 v90, v90
    v_exp_f32 v91, v91
    v_cvt_pk_bf16_f32 v114, v88, v89
    v_cvt_pk_bf16_f32 v115, v90, v91
    s_waitcnt lgkmcnt(3)
    v_mfma_f32_32x32x16_bf16 v[76:91], v[116:119], v[4:7], v[12:27]
    v_exp_f32 v92, v92
    v_exp_f32 v93, v93
    v_exp_f32 v94, v94
    v_exp_f32 v95, v95
    v_cvt_pk_bf16_f32 v108, v92, v93
    v_exp_f32 v96, v96
    v_exp_f32 v97, v97
    v_cvt_pk_bf16_f32 v109, v94, v95
    v_mfma_f32_32x32x16_bf16 v[44:59], v[160:163], v[112:115], v[44:59]
    v_exp_f32 v98, v98
    v_exp_f32 v99, v99
    v_cvt_pk_bf16_f32 v110, v96, v97
    v_exp_f32 v100, v100
    v_cvt_pk_bf16_f32 v111, v98, v99
    v_exp_f32 v101, v101
    v_exp_f32 v102, v102
    v_exp_f32 v103, v103
    v_mfma_f32_32x32x16_bf16 v[60:75], v[156:159], v[108:111], v[60:75]
    v_cvt_pk_bf16_f32 v112, v100, v101
    v_exp_f32 v104, v104
    v_exp_f32 v105, v105
    v_cvt_pk_bf16_f32 v113, v102, v103
    v_exp_f32 v106, v106
    v_exp_f32 v107, v107
    v_cvt_pk_bf16_f32 v114, v104, v105
    v_cvt_pk_bf16_f32 v115, v106, v107
    s_barrier
    v_mfma_f32_32x32x16_bf16 v[92:107], v[116:119], v[8:11], v[28:43]
    v_exp_f32 v76, v76
    v_exp_f32 v77, v77
    v_exp_f32 v78, v78
    v_exp_f32 v79, v79
    v_cvt_pk_bf16_f32 v108, v76, v77
    v_exp_f32 v80, v80
    v_exp_f32 v81, v81
    v_cvt_pk_bf16_f32 v109, v78, v79
    v_mfma_f32_32x32x16_bf16 v[60:75], v[160:163], v[112:115], v[60:75]
    v_exp_f32 v82, v82
    v_exp_f32 v83, v83
    v_cvt_pk_bf16_f32 v110, v80, v81
    ds_read_b128 v[124:127], v164 offset:4096
    ds_read_b128 v[148:151], v165 offset:4224
    ds_read_b128 v[152:155], v166 offset:4224
    v_exp_f32 v84, v84
    v_cvt_pk_bf16_f32 v111, v82, v83
    v_exp_f32 v85, v85
    v_exp_f32 v86, v86
    v_exp_f32 v87, v87
    v_mfma_f32_32x32x16_bf16 v[44:59], v[132:135], v[108:111], v[44:59]
    v_cvt_pk_bf16_f32 v112, v84, v85
    v_exp_f32 v88, v88
    v_exp_f32 v89, v89
    v_cvt_pk_bf16_f32 v113, v86, v87
    v_exp_f32 v90, v90
    v_exp_f32 v91, v91
    v_cvt_pk_bf16_f32 v114, v88, v89
    v_cvt_pk_bf16_f32 v115, v90, v91
    s_waitcnt lgkmcnt(3)
    v_mfma_f32_32x32x16_bf16 v[76:91], v[120:123], v[4:7], v[12:27]
    v_exp_f32 v92, v92
    v_exp_f32 v93, v93
    v_exp_f32 v94, v94
    v_exp_f32 v95, v95
    v_cvt_pk_bf16_f32 v108, v92, v93
    v_exp_f32 v96, v96
    v_exp_f32 v97, v97
    v_cvt_pk_bf16_f32 v109, v94, v95
    v_mfma_f32_32x32x16_bf16 v[44:59], v[136:139], v[112:115], v[44:59]
    v_exp_f32 v98, v98
    v_exp_f32 v99, v99
    v_cvt_pk_bf16_f32 v110, v96, v97
    v_exp_f32 v100, v100
    v_cvt_pk_bf16_f32 v111, v98, v99
    v_exp_f32 v101, v101
    v_exp_f32 v102, v102
    v_exp_f32 v103, v103
    v_mfma_f32_32x32x16_bf16 v[60:75], v[132:135], v[108:111], v[60:75]
    v_cvt_pk_bf16_f32 v112, v100, v101
    v_exp_f32 v104, v104
    v_exp_f32 v105, v105
    v_cvt_pk_bf16_f32 v113, v102, v103
    v_exp_f32 v106, v106
    v_exp_f32 v107, v107
    v_cvt_pk_bf16_f32 v114, v104, v105
    v_cvt_pk_bf16_f32 v115, v106, v107
    v_mfma_f32_32x32x16_bf16 v[92:107], v[120:123], v[8:11], v[28:43]
    v_exp_f32 v76, v76
    v_exp_f32 v77, v77
    v_exp_f32 v78, v78
    v_exp_f32 v79, v79
    v_cvt_pk_bf16_f32 v108, v76, v77
    v_exp_f32 v80, v80
    v_exp_f32 v81, v81
    v_cvt_pk_bf16_f32 v109, v78, v79
    v_mfma_f32_32x32x16_bf16 v[60:75], v[136:139], v[112:115], v[60:75]
    v_exp_f32 v82, v82
    v_exp_f32 v83, v83
    v_cvt_pk_bf16_f32 v110, v80, v81
    ds_read_b128 v[128:131], v164 offset:5120
    ds_read_b128 v[156:159], v165 offset:5280
    ds_read_b128 v[160:163], v166 offset:5280
    v_exp_f32 v84, v84
    v_cvt_pk_bf16_f32 v111, v82, v83
    v_exp_f32 v85, v85
    v_exp_f32 v86, v86
    v_exp_f32 v87, v87
    v_mfma_f32_32x32x16_bf16 v[44:59], v[140:143], v[108:111], v[44:59]
    v_cvt_pk_bf16_f32 v112, v84, v85
    v_exp_f32 v88, v88
    v_exp_f32 v89, v89
    v_cvt_pk_bf16_f32 v113, v86, v87
    v_exp_f32 v90, v90
    v_exp_f32 v91, v91
    v_cvt_pk_bf16_f32 v114, v88, v89
    v_cvt_pk_bf16_f32 v115, v90, v91
    s_waitcnt lgkmcnt(3)
    v_mfma_f32_32x32x16_bf16 v[76:91], v[124:127], v[4:7], v[12:27]
    v_exp_f32 v92, v92
    v_exp_f32 v93, v93
    v_exp_f32 v94, v94
    v_exp_f32 v95, v95
    v_cvt_pk_bf16_f32 v108, v92, v93
    v_exp_f32 v96, v96
    v_exp_f32 v97, v97
    v_cvt_pk_bf16_f32 v109, v94, v95
    v_mfma_f32_32x32x16_bf16 v[44:59], v[144:147], v[112:115], v[44:59]
    v_exp_f32 v98, v98
    v_exp_f32 v99, v99
    v_cvt_pk_bf16_f32 v110, v96, v97
    v_exp_f32 v100, v100
    v_cvt_pk_bf16_f32 v111, v98, v99
    v_exp_f32 v101, v101
    v_exp_f32 v102, v102
    v_exp_f32 v103, v103
    v_mfma_f32_32x32x16_bf16 v[60:75], v[140:143], v[108:111], v[60:75]
    v_cvt_pk_bf16_f32 v112, v100, v101
    v_exp_f32 v104, v104
    v_exp_f32 v105, v105
    v_cvt_pk_bf16_f32 v113, v102, v103
    v_exp_f32 v106, v106
    v_exp_f32 v107, v107
    v_cvt_pk_bf16_f32 v114, v104, v105
    v_cvt_pk_bf16_f32 v115, v106, v107
    v_mfma_f32_32x32x16_bf16 v[92:107], v[124:127], v[8:11], v[28:43]
    v_exp_f32 v76, v76
    v_exp_f32 v77, v77
    v_exp_f32 v78, v78
    v_exp_f32 v79, v79
    v_cvt_pk_bf16_f32 v108, v76, v77
    v_exp_f32 v80, v80
    v_exp_f32 v81, v81
    v_cvt_pk_bf16_f32 v109, v78, v79
    v_mfma_f32_32x32x16_bf16 v[60:75], v[144:147], v[112:115], v[60:75]
    v_exp_f32 v82, v82
    v_exp_f32 v83, v83
    v_cvt_pk_bf16_f32 v110, v80, v81
    ds_read_b128 v[116:119], v164 offset:6144
    ds_read_b128 v[132:135], v165 offset:6336
    ds_read_b128 v[136:139], v166 offset:6336
    v_exp_f32 v84, v84
    v_cvt_pk_bf16_f32 v111, v82, v83
    v_exp_f32 v85, v85
    v_exp_f32 v86, v86
    v_exp_f32 v87, v87
    v_mfma_f32_32x32x16_bf16 v[44:59], v[148:151], v[108:111], v[44:59]
    v_cvt_pk_bf16_f32 v112, v84, v85
    v_exp_f32 v88, v88
    v_exp_f32 v89, v89
    v_cvt_pk_bf16_f32 v113, v86, v87
    v_exp_f32 v90, v90
    v_exp_f32 v91, v91
    v_cvt_pk_bf16_f32 v114, v88, v89
    v_cvt_pk_bf16_f32 v115, v90, v91
    s_waitcnt lgkmcnt(3)
    v_mfma_f32_32x32x16_bf16 v[76:91], v[128:131], v[4:7], v[12:27]
    v_exp_f32 v92, v92
    v_exp_f32 v93, v93
    v_exp_f32 v94, v94
    v_exp_f32 v95, v95
    v_cvt_pk_bf16_f32 v108, v92, v93
    v_exp_f32 v96, v96
    v_exp_f32 v97, v97
    v_cvt_pk_bf16_f32 v109, v94, v95
    v_mfma_f32_32x32x16_bf16 v[44:59], v[152:155], v[112:115], v[44:59]
    v_exp_f32 v98, v98
    v_exp_f32 v99, v99
    v_cvt_pk_bf16_f32 v110, v96, v97
    v_exp_f32 v100, v100
    v_cvt_pk_bf16_f32 v111, v98, v99
    v_exp_f32 v101, v101
    v_exp_f32 v102, v102
    v_exp_f32 v103, v103
    v_mfma_f32_32x32x16_bf16 v[60:75], v[148:151], v[108:111], v[60:75]
    v_cvt_pk_bf16_f32 v112, v100, v101
    v_exp_f32 v104, v104
    v_exp_f32 v105, v105
    v_cvt_pk_bf16_f32 v113, v102, v103
    v_exp_f32 v106, v106
    v_exp_f32 v107, v107
    v_cvt_pk_bf16_f32 v114, v104, v105
    v_cvt_pk_bf16_f32 v115, v106, v107
    v_mfma_f32_32x32x16_bf16 v[92:107], v[128:131], v[8:11], v[28:43]
    v_exp_f32 v76, v76
    v_exp_f32 v77, v77
    v_exp_f32 v78, v78
    v_exp_f32 v79, v79
    v_cvt_pk_bf16_f32 v108, v76, v77
    v_exp_f32 v80, v80
    v_exp_f32 v81, v81
    v_cvt_pk_bf16_f32 v109, v78, v79
    v_mfma_f32_32x32x16_bf16 v[60:75], v[152:155], v[112:115], v[60:75]
    v_exp_f32 v82, v82
    v_exp_f32 v83, v83
    v_cvt_pk_bf16_f32 v110, v80, v81
    ds_read_b128 v[120:123], v164 offset:7168
    ds_read_b128 v[140:143], v165 offset:7392
    ds_read_b128 v[144:147], v166 offset:7392
    v_exp_f32 v84, v84
    v_cvt_pk_bf16_f32 v111, v82, v83
    v_exp_f32 v85, v85
    v_exp_f32 v86, v86
    v_exp_f32 v87, v87
    v_mfma_f32_32x32x16_bf16 v[44:59], v[156:159], v[108:111], v[44:59]
    v_cvt_pk_bf16_f32 v112, v84, v85
    v_exp_f32 v88, v88
    v_exp_f32 v89, v89
    v_cvt_pk_bf16_f32 v113, v86, v87
    v_exp_f32 v90, v90
    v_exp_f32 v91, v91
    v_cvt_pk_bf16_f32 v114, v88, v89
    v_cvt_pk_bf16_f32 v115, v90, v91
    s_waitcnt lgkmcnt(3)
    v_mfma_f32_32x32x16_bf16 v[76:91], v[116:119], v[4:7], v[12:27]
    v_exp_f32 v92, v92
    v_exp_f32 v93, v93
    v_exp_f32 v94, v94
    v_exp_f32 v95, v95
    v_cvt_pk_bf16_f32 v108, v92, v93
    v_exp_f32 v96, v96
    v_exp_f32 v97, v97
    v_cvt_pk_bf16_f32 v109, v94, v95
    v_mfma_f32_32x32x16_bf16 v[44:59], v[160:163], v[112:115], v[44:59]
    v_exp_f32 v98, v98
    v_exp_f32 v99, v99
    v_cvt_pk_bf16_f32 v110, v96, v97
    v_exp_f32 v100, v100
    v_cvt_pk_bf16_f32 v111, v98, v99
    v_exp_f32 v101, v101
    v_exp_f32 v102, v102
    v_exp_f32 v103, v103
    v_mfma_f32_32x32x16_bf16 v[60:75], v[156:159], v[108:111], v[60:75]
    v_cvt_pk_bf16_f32 v112, v100, v101
    v_exp_f32 v104, v104
    v_exp_f32 v105, v105
    v_cvt_pk_bf16_f32 v113, v102, v103
    v_exp_f32 v106, v106
    v_exp_f32 v107, v107
    v_cvt_pk_bf16_f32 v114, v104, v105
    v_cvt_pk_bf16_f32 v115, v106, v107
    v_mfma_f32_32x32x16_bf16 v[92:107], v[116:119], v[8:11], v[28:43]
    v_exp_f32 v76, v76
    v_exp_f32 v77, v77
    v_exp_f32 v78, v78
    v_exp_f32 v79, v79
    v_cvt_pk_bf16_f32 v108, v76, v77
    v_exp_f32 v80, v80
    v_exp_f32 v81, v81
    v_cvt_pk_bf16_f32 v109, v78, v79
    v_mfma_f32_32x32x16_bf16 v[60:75], v[160:163], v[112:115], v[60:75]
    v_exp_f32 v82, v82
    v_exp_f32 v83, v83
    v_cvt_pk_bf16_f32 v110, v80, v81
    ds_read_b128 v[124:127], v164 offset:8192
    ds_read_b128 v[148:151], v165 offset:8448
    ds_read_b128 v[152:155], v166 offset:8448
    v_exp_f32 v84, v84
    v_cvt_pk_bf16_f32 v111, v82, v83
    v_exp_f32 v85, v85
    v_exp_f32 v86, v86
    v_exp_f32 v87, v87
    v_mfma_f32_32x32x16_bf16 v[44:59], v[132:135], v[108:111], v[44:59]
    v_cvt_pk_bf16_f32 v112, v84, v85
    v_exp_f32 v88, v88
    v_exp_f32 v89, v89
    v_cvt_pk_bf16_f32 v113, v86, v87
    v_exp_f32 v90, v90
    v_exp_f32 v91, v91
    v_cvt_pk_bf16_f32 v114, v88, v89
    v_cvt_pk_bf16_f32 v115, v90, v91
    s_waitcnt lgkmcnt(3)
    v_mfma_f32_32x32x16_bf16 v[76:91], v[120:123], v[4:7], v[12:27]
    v_exp_f32 v92, v92
    v_exp_f32 v93, v93
    v_exp_f32 v94, v94
    v_exp_f32 v95, v95
    v_cvt_pk_bf16_f32 v108, v92, v93
    v_exp_f32 v96, v96
    v_exp_f32 v97, v97
    v_cvt_pk_bf16_f32 v109, v94, v95
    v_mfma_f32_32x32x16_bf16 v[44:59], v[136:139], v[112:115], v[44:59]
    v_exp_f32 v98, v98
    v_exp_f32 v99, v99
    v_cvt_pk_bf16_f32 v110, v96, v97
    v_exp_f32 v100, v100
    v_cvt_pk_bf16_f32 v111, v98, v99
    v_exp_f32 v101, v101
    v_exp_f32 v102, v102
    v_exp_f32 v103, v103
    v_mfma_f32_32x32x16_bf16 v[60:75], v[132:135], v[108:111], v[60:75]
    v_cvt_pk_bf16_f32 v112, v100, v101
    v_exp_f32 v104, v104
    v_exp_f32 v105, v105
    v_cvt_pk_bf16_f32 v113, v102, v103
    v_exp_f32 v106, v106
    v_exp_f32 v107, v107
    v_cvt_pk_bf16_f32 v114, v104, v105
    v_cvt_pk_bf16_f32 v115, v106, v107
    v_mfma_f32_32x32x16_bf16 v[92:107], v[120:123], v[8:11], v[28:43]
    v_exp_f32 v76, v76
    v_exp_f32 v77, v77
    v_exp_f32 v78, v78
    v_exp_f32 v79, v79
    v_cvt_pk_bf16_f32 v108, v76, v77
    v_exp_f32 v80, v80
    v_exp_f32 v81, v81
    v_cvt_pk_bf16_f32 v109, v78, v79
    v_mfma_f32_32x32x16_bf16 v[60:75], v[136:139], v[112:115], v[60:75]
    v_exp_f32 v82, v82
    v_exp_f32 v83, v83
    v_cvt_pk_bf16_f32 v110, v80, v81
    ds_read_b128 v[128:131], v164 offset:9216
    ds_read_b128 v[156:159], v165 offset:9504
    ds_read_b128 v[160:163], v166 offset:9504
    v_exp_f32 v84, v84
    v_cvt_pk_bf16_f32 v111, v82, v83
    v_exp_f32 v85, v85
    v_exp_f32 v86, v86
    v_exp_f32 v87, v87
    v_mfma_f32_32x32x16_bf16 v[44:59], v[140:143], v[108:111], v[44:59]
    v_cvt_pk_bf16_f32 v112, v84, v85
    v_exp_f32 v88, v88
    v_exp_f32 v89, v89
    v_cvt_pk_bf16_f32 v113, v86, v87
    v_exp_f32 v90, v90
    v_exp_f32 v91, v91
    v_cvt_pk_bf16_f32 v114, v88, v89
    v_cvt_pk_bf16_f32 v115, v90, v91
    s_waitcnt lgkmcnt(3)
    v_mfma_f32_32x32x16_bf16 v[76:91], v[124:127], v[4:7], v[12:27]
    v_exp_f32 v92, v92
    v_exp_f32 v93, v93
    v_exp_f32 v94, v94
    v_exp_f32 v95, v95
    v_cvt_pk_bf16_f32 v108, v92, v93
    v_exp_f32 v96, v96
    v_exp_f32 v97, v97
    v_cvt_pk_bf16_f32 v109, v94, v95
    v_mfma_f32_32x32x16_bf16 v[44:59], v[144:147], v[112:115], v[44:59]
    v_exp_f32 v98, v98
    v_exp_f32 v99, v99
    v_cvt_pk_bf16_f32 v110, v96, v97
    v_exp_f32 v100, v100
    v_cvt_pk_bf16_f32 v111, v98, v99
    v_exp_f32 v101, v101
    v_exp_f32 v102, v102
    v_exp_f32 v103, v103
    v_mfma_f32_32x32x16_bf16 v[60:75], v[140:143], v[108:111], v[60:75]
    v_cvt_pk_bf16_f32 v112, v100, v101
    v_exp_f32 v104, v104
    v_exp_f32 v105, v105
    v_cvt_pk_bf16_f32 v113, v102, v103
    v_exp_f32 v106, v106
    v_exp_f32 v107, v107
    v_cvt_pk_bf16_f32 v114, v104, v105
    v_cvt_pk_bf16_f32 v115, v106, v107
    v_mfma_f32_32x32x16_bf16 v[92:107], v[124:127], v[8:11], v[28:43]
    v_exp_f32 v76, v76
    v_exp_f32 v77, v77
    v_exp_f32 v78, v78
    v_exp_f32 v79, v79
    v_cvt_pk_bf16_f32 v108, v76, v77
    v_exp_f32 v80, v80
    v_exp_f32 v81, v81
    v_cvt_pk_bf16_f32 v109, v78, v79
    v_mfma_f32_32x32x16_bf16 v[60:75], v[144:147], v[112:115], v[60:75]
    v_exp_f32 v82, v82
    v_exp_f32 v83, v83
    v_cvt_pk_bf16_f32 v110, v80, v81
    ds_read_b128 v[116:119], v164 offset:10240
    ds_read_b128 v[132:135], v165 offset:10560
    ds_read_b128 v[136:139], v166 offset:10560
    v_exp_f32 v84, v84
    v_cvt_pk_bf16_f32 v111, v82, v83
    v_exp_f32 v85, v85
    v_exp_f32 v86, v86
    v_exp_f32 v87, v87
    v_mfma_f32_32x32x16_bf16 v[44:59], v[148:151], v[108:111], v[44:59]
    v_cvt_pk_bf16_f32 v112, v84, v85
    v_exp_f32 v88, v88
    v_exp_f32 v89, v89
    v_cvt_pk_bf16_f32 v113, v86, v87
    v_exp_f32 v90, v90
    v_exp_f32 v91, v91
    v_cvt_pk_bf16_f32 v114, v88, v89
    v_cvt_pk_bf16_f32 v115, v90, v91
    s_waitcnt lgkmcnt(3)
    v_mfma_f32_32x32x16_bf16 v[76:91], v[128:131], v[4:7], v[12:27]
    v_exp_f32 v92, v92
    v_exp_f32 v93, v93
    v_exp_f32 v94, v94
    v_exp_f32 v95, v95
    v_cvt_pk_bf16_f32 v108, v92, v93
    v_exp_f32 v96, v96
    v_exp_f32 v97, v97
    v_cvt_pk_bf16_f32 v109, v94, v95
    v_mfma_f32_32x32x16_bf16 v[44:59], v[152:155], v[112:115], v[44:59]
    v_exp_f32 v98, v98
    v_exp_f32 v99, v99
    v_cvt_pk_bf16_f32 v110, v96, v97
    v_exp_f32 v100, v100
    v_cvt_pk_bf16_f32 v111, v98, v99
    v_exp_f32 v101, v101
    v_exp_f32 v102, v102
    v_exp_f32 v103, v103
    v_mfma_f32_32x32x16_bf16 v[60:75], v[148:151], v[108:111], v[60:75]
    v_cvt_pk_bf16_f32 v112, v100, v101
    v_exp_f32 v104, v104
    v_exp_f32 v105, v105
    v_cvt_pk_bf16_f32 v113, v102, v103
    v_exp_f32 v106, v106
    v_exp_f32 v107, v107
    v_cvt_pk_bf16_f32 v114, v104, v105
    v_cvt_pk_bf16_f32 v115, v106, v107
    v_mfma_f32_32x32x16_bf16 v[92:107], v[128:131], v[8:11], v[28:43]
    v_exp_f32 v76, v76
    v_exp_f32 v77, v77
    v_exp_f32 v78, v78
    v_exp_f32 v79, v79
    v_cvt_pk_bf16_f32 v108, v76, v77
    v_exp_f32 v80, v80
    v_exp_f32 v81, v81
    v_cvt_pk_bf16_f32 v109, v78, v79
    v_mfma_f32_32x32x16_bf16 v[60:75], v[152:155], v[112:115], v[60:75]
    v_exp_f32 v82, v82
    v_exp_f32 v83, v83
    v_cvt_pk_bf16_f32 v110, v80, v81
    ds_read_b128 v[120:123], v164 offset:11264
    ds_read_b128 v[140:143], v165 offset:11616
    ds_read_b128 v[144:147], v166 offset:11616
    v_exp_f32 v84, v84
    v_cvt_pk_bf16_f32 v111, v82, v83
    v_exp_f32 v85, v85
    v_exp_f32 v86, v86
    v_exp_f32 v87, v87
    v_mfma_f32_32x32x16_bf16 v[44:59], v[156:159], v[108:111], v[44:59]
    v_cvt_pk_bf16_f32 v112, v84, v85
    v_exp_f32 v88, v88
    v_exp_f32 v89, v89
    v_cvt_pk_bf16_f32 v113, v86, v87
    v_exp_f32 v90, v90
    v_exp_f32 v91, v91
    v_cvt_pk_bf16_f32 v114, v88, v89
    v_cvt_pk_bf16_f32 v115, v90, v91
    s_waitcnt lgkmcnt(3)
    v_mfma_f32_32x32x16_bf16 v[76:91], v[116:119], v[4:7], v[12:27]
    v_exp_f32 v92, v92
    v_exp_f32 v93, v93
    v_exp_f32 v94, v94
    v_exp_f32 v95, v95
    v_cvt_pk_bf16_f32 v108, v92, v93
    v_exp_f32 v96, v96
    v_exp_f32 v97, v97
    v_cvt_pk_bf16_f32 v109, v94, v95
    v_mfma_f32_32x32x16_bf16 v[44:59], v[160:163], v[112:115], v[44:59]
    v_exp_f32 v98, v98
    v_exp_f32 v99, v99
    v_cvt_pk_bf16_f32 v110, v96, v97
    v_exp_f32 v100, v100
    v_cvt_pk_bf16_f32 v111, v98, v99
    v_exp_f32 v101, v101
    v_exp_f32 v102, v102
    v_exp_f32 v103, v103
    v_mfma_f32_32x32x16_bf16 v[60:75], v[156:159], v[108:111], v[60:75]
    v_cvt_pk_bf16_f32 v112, v100, v101
    v_exp_f32 v104, v104
    v_exp_f32 v105, v105
    v_cvt_pk_bf16_f32 v113, v102, v103
    v_exp_f32 v106, v106
    v_exp_f32 v107, v107
    v_cvt_pk_bf16_f32 v114, v104, v105
    v_cvt_pk_bf16_f32 v115, v106, v107
    v_mfma_f32_32x32x16_bf16 v[92:107], v[116:119], v[8:11], v[28:43]
    v_exp_f32 v76, v76
    v_exp_f32 v77, v77
    v_exp_f32 v78, v78
    v_exp_f32 v79, v79
    v_cvt_pk_bf16_f32 v108, v76, v77
    v_exp_f32 v80, v80
    v_exp_f32 v81, v81
    v_cvt_pk_bf16_f32 v109, v78, v79
    v_mfma_f32_32x32x16_bf16 v[60:75], v[160:163], v[112:115], v[60:75]
    v_exp_f32 v82, v82
    v_exp_f32 v83, v83
    v_cvt_pk_bf16_f32 v110, v80, v81
    ds_read_b128 v[124:127], v164 offset:12288
    ds_read_b128 v[148:151], v165 offset:12672
    ds_read_b128 v[152:155], v166 offset:12672
    v_exp_f32 v84, v84
    v_cvt_pk_bf16_f32 v111, v82, v83
    v_exp_f32 v85, v85
    v_exp_f32 v86, v86
    v_exp_f32 v87, v87
    v_mfma_f32_32x32x16_bf16 v[44:59], v[132:135], v[108:111], v[44:59]
    v_cvt_pk_bf16_f32 v112, v84, v85
    v_exp_f32 v88, v88
    v_exp_f32 v89, v89
    v_cvt_pk_bf16_f32 v113, v86, v87
    v_exp_f32 v90, v90
    v_exp_f32 v91, v91
    v_cvt_pk_bf16_f32 v114, v88, v89
    v_cvt_pk_bf16_f32 v115, v90, v91
    s_waitcnt lgkmcnt(3)
    v_mfma_f32_32x32x16_bf16 v[76:91], v[120:123], v[4:7], v[12:27]
    v_exp_f32 v92, v92
    v_exp_f32 v93, v93
    v_exp_f32 v94, v94
    v_exp_f32 v95, v95
    v_cvt_pk_bf16_f32 v108, v92, v93
    v_exp_f32 v96, v96
    v_exp_f32 v97, v97
    v_cvt_pk_bf16_f32 v109, v94, v95
    v_mfma_f32_32x32x16_bf16 v[44:59], v[136:139], v[112:115], v[44:59]
    v_exp_f32 v98, v98
    v_exp_f32 v99, v99
    v_cvt_pk_bf16_f32 v110, v96, v97
    v_exp_f32 v100, v100
    v_cvt_pk_bf16_f32 v111, v98, v99
    v_exp_f32 v101, v101
    v_exp_f32 v102, v102
    v_exp_f32 v103, v103
    v_mfma_f32_32x32x16_bf16 v[60:75], v[132:135], v[108:111], v[60:75]
    v_cvt_pk_bf16_f32 v112, v100, v101
    v_exp_f32 v104, v104
    v_exp_f32 v105, v105
    v_cvt_pk_bf16_f32 v113, v102, v103
    v_exp_f32 v106, v106
    v_exp_f32 v107, v107
    v_cvt_pk_bf16_f32 v114, v104, v105
    v_cvt_pk_bf16_f32 v115, v106, v107
    v_mfma_f32_32x32x16_bf16 v[92:107], v[120:123], v[8:11], v[28:43]
    v_exp_f32 v76, v76
    v_exp_f32 v77, v77
    v_exp_f32 v78, v78
    v_exp_f32 v79, v79
    v_cvt_pk_bf16_f32 v108, v76, v77
    v_exp_f32 v80, v80
    v_exp_f32 v81, v81
    v_cvt_pk_bf16_f32 v109, v78, v79
    v_mfma_f32_32x32x16_bf16 v[60:75], v[136:139], v[112:115], v[60:75]
    v_exp_f32 v82, v82
    v_exp_f32 v83, v83
    v_cvt_pk_bf16_f32 v110, v80, v81
    ds_read_b128 v[128:131], v164 offset:13312
    ds_read_b128 v[156:159], v165 offset:13728
    ds_read_b128 v[160:163], v166 offset:13728
    v_exp_f32 v84, v84
    v_cvt_pk_bf16_f32 v111, v82, v83
    v_exp_f32 v85, v85
    v_exp_f32 v86, v86
    v_exp_f32 v87, v87
    v_mfma_f32_32x32x16_bf16 v[44:59], v[140:143], v[108:111], v[44:59]
    v_cvt_pk_bf16_f32 v112, v84, v85
    v_exp_f32 v88, v88
    v_exp_f32 v89, v89
    v_cvt_pk_bf16_f32 v113, v86, v87
    v_exp_f32 v90, v90
    v_exp_f32 v91, v91
    v_cvt_pk_bf16_f32 v114, v88, v89
    v_cvt_pk_bf16_f32 v115, v90, v91
    s_waitcnt lgkmcnt(3)
    v_mfma_f32_32x32x16_bf16 v[76:91], v[124:127], v[4:7], v[12:27]
    v_exp_f32 v92, v92
    v_exp_f32 v93, v93
    v_exp_f32 v94, v94
    v_exp_f32 v95, v95
    v_cvt_pk_bf16_f32 v108, v92, v93
    v_exp_f32 v96, v96
    v_exp_f32 v97, v97
    v_cvt_pk_bf16_f32 v109, v94, v95
    v_mfma_f32_32x32x16_bf16 v[44:59], v[144:147], v[112:115], v[44:59]
    v_exp_f32 v98, v98
    v_exp_f32 v99, v99
    v_cvt_pk_bf16_f32 v110, v96, v97
    v_exp_f32 v100, v100
    v_cvt_pk_bf16_f32 v111, v98, v99
    v_exp_f32 v101, v101
    v_exp_f32 v102, v102
    v_exp_f32 v103, v103
    v_mfma_f32_32x32x16_bf16 v[60:75], v[140:143], v[108:111], v[60:75]
    v_cvt_pk_bf16_f32 v112, v100, v101
    v_exp_f32 v104, v104
    v_exp_f32 v105, v105
    v_cvt_pk_bf16_f32 v113, v102, v103
    v_exp_f32 v106, v106
    v_exp_f32 v107, v107
    v_cvt_pk_bf16_f32 v114, v104, v105
    v_cvt_pk_bf16_f32 v115, v106, v107
    v_mfma_f32_32x32x16_bf16 v[92:107], v[124:127], v[8:11], v[28:43]
    v_exp_f32 v76, v76
    v_exp_f32 v77, v77
    v_exp_f32 v78, v78
    v_exp_f32 v79, v79
    v_cvt_pk_bf16_f32 v108, v76, v77
    v_exp_f32 v80, v80
    v_exp_f32 v81, v81
    v_cvt_pk_bf16_f32 v109, v78, v79
    v_mfma_f32_32x32x16_bf16 v[60:75], v[144:147], v[112:115], v[60:75]
    v_exp_f32 v82, v82
    v_exp_f32 v83, v83
    v_cvt_pk_bf16_f32 v110, v80, v81
    ds_read_b128 v[116:119], v164 offset:14336
    ds_read_b128 v[132:135], v165 offset:14784
    ds_read_b128 v[136:139], v166 offset:14784
    v_exp_f32 v84, v84
    v_cvt_pk_bf16_f32 v111, v82, v83
    v_exp_f32 v85, v85
    v_exp_f32 v86, v86
    v_exp_f32 v87, v87
    v_mfma_f32_32x32x16_bf16 v[44:59], v[148:151], v[108:111], v[44:59]
    v_cvt_pk_bf16_f32 v112, v84, v85
    v_exp_f32 v88, v88
    v_exp_f32 v89, v89
    v_cvt_pk_bf16_f32 v113, v86, v87
    v_exp_f32 v90, v90
    v_exp_f32 v91, v91
    v_cvt_pk_bf16_f32 v114, v88, v89
    v_cvt_pk_bf16_f32 v115, v90, v91
    s_waitcnt lgkmcnt(3)
    v_mfma_f32_32x32x16_bf16 v[76:91], v[128:131], v[4:7], v[12:27]
    v_exp_f32 v92, v92
    v_exp_f32 v93, v93
    v_exp_f32 v94, v94
    v_exp_f32 v95, v95
    v_cvt_pk_bf16_f32 v108, v92, v93
    v_exp_f32 v96, v96
    v_exp_f32 v97, v97
    v_cvt_pk_bf16_f32 v109, v94, v95
    v_mfma_f32_32x32x16_bf16 v[44:59], v[152:155], v[112:115], v[44:59]
    v_exp_f32 v98, v98
    v_exp_f32 v99, v99
    v_cvt_pk_bf16_f32 v110, v96, v97
    v_exp_f32 v100, v100
    v_cvt_pk_bf16_f32 v111, v98, v99
    v_exp_f32 v101, v101
    v_exp_f32 v102, v102
    v_exp_f32 v103, v103
    v_mfma_f32_32x32x16_bf16 v[60:75], v[148:151], v[108:111], v[60:75]
    v_cvt_pk_bf16_f32 v112, v100, v101
    v_exp_f32 v104, v104
    v_exp_f32 v105, v105
    v_cvt_pk_bf16_f32 v113, v102, v103
    v_exp_f32 v106, v106
    v_exp_f32 v107, v107
    v_cvt_pk_bf16_f32 v114, v104, v105
    v_cvt_pk_bf16_f32 v115, v106, v107
    v_mfma_f32_32x32x16_bf16 v[92:107], v[128:131], v[8:11], v[28:43]
    v_exp_f32 v76, v76
    v_exp_f32 v77, v77
    v_exp_f32 v78, v78
    v_exp_f32 v79, v79
    v_cvt_pk_bf16_f32 v108, v76, v77
    v_exp_f32 v80, v80
    v_exp_f32 v81, v81
    v_cvt_pk_bf16_f32 v109, v78, v79
    v_mfma_f32_32x32x16_bf16 v[60:75], v[152:155], v[112:115], v[60:75]
    v_exp_f32 v82, v82
    v_exp_f32 v83, v83
    v_cvt_pk_bf16_f32 v110, v80, v81
    ds_read_b128 v[120:123], v164 offset:15360
    ds_read_b128 v[140:143], v165 offset:15840
    ds_read_b128 v[144:147], v166 offset:15840
    v_exp_f32 v84, v84
    v_cvt_pk_bf16_f32 v111, v82, v83
    v_exp_f32 v85, v85
    v_exp_f32 v86, v86
    v_exp_f32 v87, v87
    v_mfma_f32_32x32x16_bf16 v[44:59], v[156:159], v[108:111], v[44:59]
    v_cvt_pk_bf16_f32 v112, v84, v85
    v_exp_f32 v88, v88
    v_exp_f32 v89, v89
    v_cvt_pk_bf16_f32 v113, v86, v87
    v_exp_f32 v90, v90
    v_exp_f32 v91, v91
    v_cvt_pk_bf16_f32 v114, v88, v89
    v_cvt_pk_bf16_f32 v115, v90, v91
    s_waitcnt lgkmcnt(3)
    v_mfma_f32_32x32x16_bf16 v[76:91], v[116:119], v[4:7], v[12:27]
    v_exp_f32 v92, v92
    v_exp_f32 v93, v93
    v_exp_f32 v94, v94
    v_exp_f32 v95, v95
    v_cvt_pk_bf16_f32 v108, v92, v93
    v_exp_f32 v96, v96
    v_exp_f32 v97, v97
    v_cvt_pk_bf16_f32 v109, v94, v95
    v_mfma_f32_32x32x16_bf16 v[44:59], v[160:163], v[112:115], v[44:59]
    v_exp_f32 v98, v98
    v_exp_f32 v99, v99
    v_cvt_pk_bf16_f32 v110, v96, v97
    v_exp_f32 v100, v100
    v_cvt_pk_bf16_f32 v111, v98, v99
    v_exp_f32 v101, v101
    v_exp_f32 v102, v102
    v_exp_f32 v103, v103
    v_mfma_f32_32x32x16_bf16 v[60:75], v[156:159], v[108:111], v[60:75]
    v_cvt_pk_bf16_f32 v112, v100, v101
    v_exp_f32 v104, v104
    v_exp_f32 v105, v105
    v_cvt_pk_bf16_f32 v113, v102, v103
    v_exp_f32 v106, v106
    v_exp_f32 v107, v107
    v_cvt_pk_bf16_f32 v114, v104, v105
    v_cvt_pk_bf16_f32 v115, v106, v107
    v_mfma_f32_32x32x16_bf16 v[92:107], v[116:119], v[8:11], v[28:43]
    v_exp_f32 v76, v76
    v_exp_f32 v77, v77
    v_exp_f32 v78, v78
    v_exp_f32 v79, v79
    v_cvt_pk_bf16_f32 v108, v76, v77
    v_exp_f32 v80, v80
    v_exp_f32 v81, v81
    v_cvt_pk_bf16_f32 v109, v78, v79
    v_mfma_f32_32x32x16_bf16 v[60:75], v[160:163], v[112:115], v[60:75]
    v_exp_f32 v82, v82
    v_exp_f32 v83, v83
    v_cvt_pk_bf16_f32 v110, v80, v81
    ds_read_b128 v[124:127], v164 offset:16384
    ds_read_b128 v[148:151], v165 offset:16896
    ds_read_b128 v[152:155], v166 offset:16896
    v_exp_f32 v84, v84
    v_cvt_pk_bf16_f32 v111, v82, v83
    v_exp_f32 v85, v85
    v_exp_f32 v86, v86
    v_exp_f32 v87, v87
    v_mfma_f32_32x32x16_bf16 v[44:59], v[132:135], v[108:111], v[44:59]
    v_cvt_pk_bf16_f32 v112, v84, v85
    v_exp_f32 v88, v88
    v_exp_f32 v89, v89
    v_cvt_pk_bf16_f32 v113, v86, v87
    v_exp_f32 v90, v90
    v_exp_f32 v91, v91
    v_cvt_pk_bf16_f32 v114, v88, v89
    v_cvt_pk_bf16_f32 v115, v90, v91
    s_waitcnt lgkmcnt(3)
    v_mfma_f32_32x32x16_bf16 v[76:91], v[120:123], v[4:7], v[12:27]
    v_exp_f32 v92, v92
    v_exp_f32 v93, v93
    v_exp_f32 v94, v94
    v_exp_f32 v95, v95
    v_cvt_pk_bf16_f32 v108, v92, v93
    v_exp_f32 v96, v96
    v_exp_f32 v97, v97
    v_cvt_pk_bf16_f32 v109, v94, v95
    v_mfma_f32_32x32x16_bf16 v[44:59], v[136:139], v[112:115], v[44:59]
    v_exp_f32 v98, v98
    v_exp_f32 v99, v99
    v_cvt_pk_bf16_f32 v110, v96, v97
    v_exp_f32 v100, v100
    v_cvt_pk_bf16_f32 v111, v98, v99
    v_exp_f32 v101, v101
    v_exp_f32 v102, v102
    v_exp_f32 v103, v103
    v_mfma_f32_32x32x16_bf16 v[60:75], v[132:135], v[108:111], v[60:75]
    v_cvt_pk_bf16_f32 v112, v100, v101
    v_exp_f32 v104, v104
    v_exp_f32 v105, v105
    v_cvt_pk_bf16_f32 v113, v102, v103
    v_exp_f32 v106, v106
    v_exp_f32 v107, v107
    v_cvt_pk_bf16_f32 v114, v104, v105
    v_cvt_pk_bf16_f32 v115, v106, v107
    v_mfma_f32_32x32x16_bf16 v[92:107], v[120:123], v[8:11], v[28:43]
    v_exp_f32 v76, v76
    v_exp_f32 v77, v77
    v_exp_f32 v78, v78
    v_exp_f32 v79, v79
    v_cvt_pk_bf16_f32 v108, v76, v77
    v_exp_f32 v80, v80
    v_exp_f32 v81, v81
    v_cvt_pk_bf16_f32 v109, v78, v79
    v_mfma_f32_32x32x16_bf16 v[60:75], v[136:139], v[112:115], v[60:75]
    v_exp_f32 v82, v82
    v_exp_f32 v83, v83
    v_cvt_pk_bf16_f32 v110, v80, v81
    ds_read_b128 v[128:131], v164 offset:17408
    ds_read_b128 v[156:159], v165 offset:17952
    ds_read_b128 v[160:163], v166 offset:17952
    v_exp_f32 v84, v84
    v_cvt_pk_bf16_f32 v111, v82, v83
    v_exp_f32 v85, v85
    v_exp_f32 v86, v86
    v_exp_f32 v87, v87
    v_mfma_f32_32x32x16_bf16 v[44:59], v[140:143], v[108:111], v[44:59]
    v_cvt_pk_bf16_f32 v112, v84, v85
    v_exp_f32 v88, v88
    v_exp_f32 v89, v89
    v_cvt_pk_bf16_f32 v113, v86, v87
    v_exp_f32 v90, v90
    v_exp_f32 v91, v91
    v_cvt_pk_bf16_f32 v114, v88, v89
    v_cvt_pk_bf16_f32 v115, v90, v91
    s_waitcnt lgkmcnt(3)
    v_mfma_f32_32x32x16_bf16 v[76:91], v[124:127], v[4:7], v[12:27]
    v_exp_f32 v92, v92
    v_exp_f32 v93, v93
    v_exp_f32 v94, v94
    v_exp_f32 v95, v95
    v_cvt_pk_bf16_f32 v108, v92, v93
    v_exp_f32 v96, v96
    v_exp_f32 v97, v97
    v_cvt_pk_bf16_f32 v109, v94, v95
    v_mfma_f32_32x32x16_bf16 v[44:59], v[144:147], v[112:115], v[44:59]
    v_exp_f32 v98, v98
    v_exp_f32 v99, v99
    v_cvt_pk_bf16_f32 v110, v96, v97
    v_exp_f32 v100, v100
    v_cvt_pk_bf16_f32 v111, v98, v99
    v_exp_f32 v101, v101
    v_exp_f32 v102, v102
    v_exp_f32 v103, v103
    v_mfma_f32_32x32x16_bf16 v[60:75], v[140:143], v[108:111], v[60:75]
    v_cvt_pk_bf16_f32 v112, v100, v101
    v_exp_f32 v104, v104
    v_exp_f32 v105, v105
    v_cvt_pk_bf16_f32 v113, v102, v103
    v_exp_f32 v106, v106
    v_exp_f32 v107, v107
    v_cvt_pk_bf16_f32 v114, v104, v105
    v_cvt_pk_bf16_f32 v115, v106, v107
    v_mfma_f32_32x32x16_bf16 v[92:107], v[124:127], v[8:11], v[28:43]
    v_exp_f32 v76, v76
    v_exp_f32 v77, v77
    v_exp_f32 v78, v78
    v_exp_f32 v79, v79
    v_cvt_pk_bf16_f32 v108, v76, v77
    v_exp_f32 v80, v80
    v_exp_f32 v81, v81
    v_cvt_pk_bf16_f32 v109, v78, v79
    v_mfma_f32_32x32x16_bf16 v[60:75], v[144:147], v[112:115], v[60:75]
    v_exp_f32 v82, v82
    v_exp_f32 v83, v83
    v_cvt_pk_bf16_f32 v110, v80, v81
    ds_read_b128 v[116:119], v164 offset:18432
    ds_read_b128 v[132:135], v165 offset:19008
    ds_read_b128 v[136:139], v166 offset:19008
    v_exp_f32 v84, v84
    v_cvt_pk_bf16_f32 v111, v82, v83
    v_exp_f32 v85, v85
    v_exp_f32 v86, v86
    v_exp_f32 v87, v87
    v_mfma_f32_32x32x16_bf16 v[44:59], v[148:151], v[108:111], v[44:59]
    v_cvt_pk_bf16_f32 v112, v84, v85
    v_exp_f32 v88, v88
    v_exp_f32 v89, v89
    v_cvt_pk_bf16_f32 v113, v86, v87
    v_exp_f32 v90, v90
    v_exp_f32 v91, v91
    v_cvt_pk_bf16_f32 v114, v88, v89
    v_cvt_pk_bf16_f32 v115, v90, v91
    s_waitcnt lgkmcnt(3)
    v_mfma_f32_32x32x16_bf16 v[76:91], v[128:131], v[4:7], v[12:27]
    v_exp_f32 v92, v92
    v_exp_f32 v93, v93
    v_exp_f32 v94, v94
    v_exp_f32 v95, v95
    v_cvt_pk_bf16_f32 v108, v92, v93
    v_exp_f32 v96, v96
    v_exp_f32 v97, v97
    v_cvt_pk_bf16_f32 v109, v94, v95
    v_mfma_f32_32x32x16_bf16 v[44:59], v[152:155], v[112:115], v[44:59]
    v_exp_f32 v98, v98
    v_exp_f32 v99, v99
    v_cvt_pk_bf16_f32 v110, v96, v97
    v_exp_f32 v100, v100
    v_cvt_pk_bf16_f32 v111, v98, v99
    v_exp_f32 v101, v101
    v_exp_f32 v102, v102
    v_exp_f32 v103, v103
    v_mfma_f32_32x32x16_bf16 v[60:75], v[148:151], v[108:111], v[60:75]
    v_cvt_pk_bf16_f32 v112, v100, v101
    v_exp_f32 v104, v104
    v_exp_f32 v105, v105
    v_cvt_pk_bf16_f32 v113, v102, v103
    v_exp_f32 v106, v106
    v_exp_f32 v107, v107
    v_cvt_pk_bf16_f32 v114, v104, v105
    v_cvt_pk_bf16_f32 v115, v106, v107
    v_mfma_f32_32x32x16_bf16 v[92:107], v[128:131], v[8:11], v[28:43]
    v_exp_f32 v76, v76
    v_exp_f32 v77, v77
    v_exp_f32 v78, v78
    v_exp_f32 v79, v79
    v_cvt_pk_bf16_f32 v108, v76, v77
    v_exp_f32 v80, v80
    v_exp_f32 v81, v81
    v_cvt_pk_bf16_f32 v109, v78, v79
    v_mfma_f32_32x32x16_bf16 v[60:75], v[152:155], v[112:115], v[60:75]
    v_exp_f32 v82, v82
    v_exp_f32 v83, v83
    v_cvt_pk_bf16_f32 v110, v80, v81
    ds_read_b128 v[120:123], v164 offset:19456
    ds_read_b128 v[140:143], v165 offset:20064
    ds_read_b128 v[144:147], v166 offset:20064
    v_exp_f32 v84, v84
    v_cvt_pk_bf16_f32 v111, v82, v83
    v_exp_f32 v85, v85
    v_exp_f32 v86, v86
    v_exp_f32 v87, v87
    v_mfma_f32_32x32x16_bf16 v[44:59], v[156:159], v[108:111], v[44:59]
    v_cvt_pk_bf16_f32 v112, v84, v85
    v_exp_f32 v88, v88
    v_exp_f32 v89, v89
    v_cvt_pk_bf16_f32 v113, v86, v87
    v_exp_f32 v90, v90
    v_exp_f32 v91, v91
    v_cvt_pk_bf16_f32 v114, v88, v89
    v_cvt_pk_bf16_f32 v115, v90, v91
    s_waitcnt lgkmcnt(3)
    v_mfma_f32_32x32x16_bf16 v[76:91], v[116:119], v[4:7], v[12:27]
    v_exp_f32 v92, v92
    v_exp_f32 v93, v93
    v_exp_f32 v94, v94
    v_exp_f32 v95, v95
    v_cvt_pk_bf16_f32 v108, v92, v93
    v_exp_f32 v96, v96
    v_exp_f32 v97, v97
    v_cvt_pk_bf16_f32 v109, v94, v95
    v_mfma_f32_32x32x16_bf16 v[44:59], v[160:163], v[112:115], v[44:59]
    v_exp_f32 v98, v98
    v_exp_f32 v99, v99
    v_cvt_pk_bf16_f32 v110, v96, v97
    v_exp_f32 v100, v100
    v_cvt_pk_bf16_f32 v111, v98, v99
    v_exp_f32 v101, v101
    v_exp_f32 v102, v102
    v_exp_f32 v103, v103
    v_mfma_f32_32x32x16_bf16 v[60:75], v[156:159], v[108:111], v[60:75]
    v_cvt_pk_bf16_f32 v112, v100, v101
    v_exp_f32 v104, v104
    v_exp_f32 v105, v105
    v_cvt_pk_bf16_f32 v113, v102, v103
    v_exp_f32 v106, v106
    v_exp_f32 v107, v107
    v_cvt_pk_bf16_f32 v114, v104, v105
    v_cvt_pk_bf16_f32 v115, v106, v107
    v_mfma_f32_32x32x16_bf16 v[92:107], v[116:119], v[8:11], v[28:43]
    v_exp_f32 v76, v76
    v_exp_f32 v77, v77
    v_exp_f32 v78, v78
    v_exp_f32 v79, v79
    v_cvt_pk_bf16_f32 v108, v76, v77
    v_exp_f32 v80, v80
    v_exp_f32 v81, v81
    v_cvt_pk_bf16_f32 v109, v78, v79
    v_mfma_f32_32x32x16_bf16 v[60:75], v[160:163], v[112:115], v[60:75]
    v_exp_f32 v82, v82
    v_exp_f32 v83, v83
    v_cvt_pk_bf16_f32 v110, v80, v81
    ds_read_b128 v[124:127], v164 offset:20480
    ds_read_b128 v[148:151], v165 offset:21120
    ds_read_b128 v[152:155], v166 offset:21120
    v_exp_f32 v84, v84
    v_cvt_pk_bf16_f32 v111, v82, v83
    v_exp_f32 v85, v85
    v_exp_f32 v86, v86
    v_exp_f32 v87, v87
    v_mfma_f32_32x32x16_bf16 v[44:59], v[132:135], v[108:111], v[44:59]
    v_cvt_pk_bf16_f32 v112, v84, v85
    v_exp_f32 v88, v88
    v_exp_f32 v89, v89
    v_cvt_pk_bf16_f32 v113, v86, v87
    v_exp_f32 v90, v90
    v_exp_f32 v91, v91
    v_cvt_pk_bf16_f32 v114, v88, v89
    v_cvt_pk_bf16_f32 v115, v90, v91
    s_waitcnt lgkmcnt(3)
    v_mfma_f32_32x32x16_bf16 v[76:91], v[120:123], v[4:7], v[12:27]
    v_exp_f32 v92, v92
    v_exp_f32 v93, v93
    v_exp_f32 v94, v94
    v_exp_f32 v95, v95
    v_cvt_pk_bf16_f32 v108, v92, v93
    v_exp_f32 v96, v96
    v_exp_f32 v97, v97
    v_cvt_pk_bf16_f32 v109, v94, v95
    v_mfma_f32_32x32x16_bf16 v[44:59], v[136:139], v[112:115], v[44:59]
    v_exp_f32 v98, v98
    v_exp_f32 v99, v99
    v_cvt_pk_bf16_f32 v110, v96, v97
    v_exp_f32 v100, v100
    v_cvt_pk_bf16_f32 v111, v98, v99
    v_exp_f32 v101, v101
    v_exp_f32 v102, v102
    v_exp_f32 v103, v103
    v_mfma_f32_32x32x16_bf16 v[60:75], v[132:135], v[108:111], v[60:75]
    v_cvt_pk_bf16_f32 v112, v100, v101
    v_exp_f32 v104, v104
    v_exp_f32 v105, v105
    v_cvt_pk_bf16_f32 v113, v102, v103
    v_exp_f32 v106, v106
    v_exp_f32 v107, v107
    v_cvt_pk_bf16_f32 v114, v104, v105
    v_cvt_pk_bf16_f32 v115, v106, v107
    v_mfma_f32_32x32x16_bf16 v[92:107], v[120:123], v[8:11], v[28:43]
    v_exp_f32 v76, v76
    v_exp_f32 v77, v77
    v_exp_f32 v78, v78
    v_exp_f32 v79, v79
    v_cvt_pk_bf16_f32 v108, v76, v77
    v_exp_f32 v80, v80
    v_exp_f32 v81, v81
    v_cvt_pk_bf16_f32 v109, v78, v79
    v_mfma_f32_32x32x16_bf16 v[60:75], v[136:139], v[112:115], v[60:75]
    v_exp_f32 v82, v82
    v_exp_f32 v83, v83
    v_cvt_pk_bf16_f32 v110, v80, v81
    ds_read_b128 v[128:131], v164 offset:21504
    ds_read_b128 v[156:159], v165 offset:22176
    ds_read_b128 v[160:163], v166 offset:22176
    v_exp_f32 v84, v84
    v_cvt_pk_bf16_f32 v111, v82, v83
    v_exp_f32 v85, v85
    v_exp_f32 v86, v86
    v_exp_f32 v87, v87
    v_mfma_f32_32x32x16_bf16 v[44:59], v[140:143], v[108:111], v[44:59]
    v_cvt_pk_bf16_f32 v112, v84, v85
    v_exp_f32 v88, v88
    v_exp_f32 v89, v89
    v_cvt_pk_bf16_f32 v113, v86, v87
    v_exp_f32 v90, v90
    v_exp_f32 v91, v91
    v_cvt_pk_bf16_f32 v114, v88, v89
    v_cvt_pk_bf16_f32 v115, v90, v91
    s_waitcnt lgkmcnt(3)
    v_mfma_f32_32x32x16_bf16 v[76:91], v[124:127], v[4:7], v[12:27]
    v_exp_f32 v92, v92
    v_exp_f32 v93, v93
    v_exp_f32 v94, v94
    v_exp_f32 v95, v95
    v_cvt_pk_bf16_f32 v108, v92, v93
    v_exp_f32 v96, v96
    v_exp_f32 v97, v97
    v_cvt_pk_bf16_f32 v109, v94, v95
    v_mfma_f32_32x32x16_bf16 v[44:59], v[144:147], v[112:115], v[44:59]
    v_exp_f32 v98, v98
    v_exp_f32 v99, v99
    v_cvt_pk_bf16_f32 v110, v96, v97
    v_exp_f32 v100, v100
    v_cvt_pk_bf16_f32 v111, v98, v99
    v_exp_f32 v101, v101
    v_exp_f32 v102, v102
    v_exp_f32 v103, v103
    v_mfma_f32_32x32x16_bf16 v[60:75], v[140:143], v[108:111], v[60:75]
    v_cvt_pk_bf16_f32 v112, v100, v101
    v_exp_f32 v104, v104
    v_exp_f32 v105, v105
    v_cvt_pk_bf16_f32 v113, v102, v103
    v_exp_f32 v106, v106
    v_exp_f32 v107, v107
    v_cvt_pk_bf16_f32 v114, v104, v105
    v_cvt_pk_bf16_f32 v115, v106, v107
    v_mfma_f32_32x32x16_bf16 v[92:107], v[124:127], v[8:11], v[28:43]
    v_exp_f32 v76, v76
    v_exp_f32 v77, v77
    v_exp_f32 v78, v78
    v_exp_f32 v79, v79
    v_cvt_pk_bf16_f32 v108, v76, v77
    v_exp_f32 v80, v80
    v_exp_f32 v81, v81
    v_cvt_pk_bf16_f32 v109, v78, v79
    v_mfma_f32_32x32x16_bf16 v[60:75], v[144:147], v[112:115], v[60:75]
    v_exp_f32 v82, v82
    v_exp_f32 v83, v83
    v_cvt_pk_bf16_f32 v110, v80, v81
    ds_read_b128 v[116:119], v164 offset:22528
    ds_read_b128 v[132:135], v165 offset:23232
    ds_read_b128 v[136:139], v166 offset:23232
    v_exp_f32 v84, v84
    v_cvt_pk_bf16_f32 v111, v82, v83
    v_exp_f32 v85, v85
    v_exp_f32 v86, v86
    v_exp_f32 v87, v87
    v_mfma_f32_32x32x16_bf16 v[44:59], v[148:151], v[108:111], v[44:59]
    v_cvt_pk_bf16_f32 v112, v84, v85
    v_exp_f32 v88, v88
    v_exp_f32 v89, v89
    v_cvt_pk_bf16_f32 v113, v86, v87
    v_exp_f32 v90, v90
    v_exp_f32 v91, v91
    v_cvt_pk_bf16_f32 v114, v88, v89
    v_cvt_pk_bf16_f32 v115, v90, v91
    s_waitcnt lgkmcnt(3)
    v_mfma_f32_32x32x16_bf16 v[76:91], v[128:131], v[4:7], v[12:27]
    v_exp_f32 v92, v92
    v_exp_f32 v93, v93
    v_exp_f32 v94, v94
    v_exp_f32 v95, v95
    v_cvt_pk_bf16_f32 v108, v92, v93
    v_exp_f32 v96, v96
    v_exp_f32 v97, v97
    v_cvt_pk_bf16_f32 v109, v94, v95
    v_mfma_f32_32x32x16_bf16 v[44:59], v[152:155], v[112:115], v[44:59]
    v_exp_f32 v98, v98
    v_exp_f32 v99, v99
    v_cvt_pk_bf16_f32 v110, v96, v97
    v_exp_f32 v100, v100
    v_cvt_pk_bf16_f32 v111, v98, v99
    v_exp_f32 v101, v101
    v_exp_f32 v102, v102
    v_exp_f32 v103, v103
    v_mfma_f32_32x32x16_bf16 v[60:75], v[148:151], v[108:111], v[60:75]
    v_cvt_pk_bf16_f32 v112, v100, v101
    v_exp_f32 v104, v104
    v_exp_f32 v105, v105
    v_cvt_pk_bf16_f32 v113, v102, v103
    v_exp_f32 v106, v106
    v_exp_f32 v107, v107
    v_cvt_pk_bf16_f32 v114, v104, v105
    v_cvt_pk_bf16_f32 v115, v106, v107
    v_mfma_f32_32x32x16_bf16 v[92:107], v[128:131], v[8:11], v[28:43]
    v_exp_f32 v76, v76
    v_exp_f32 v77, v77
    v_exp_f32 v78, v78
    v_exp_f32 v79, v79
    v_cvt_pk_bf16_f32 v108, v76, v77
    v_exp_f32 v80, v80
    v_exp_f32 v81, v81
    v_cvt_pk_bf16_f32 v109, v78, v79
    v_mfma_f32_32x32x16_bf16 v[60:75], v[152:155], v[112:115], v[60:75]
    v_exp_f32 v82, v82
    v_exp_f32 v83, v83
    v_cvt_pk_bf16_f32 v110, v80, v81
    ds_read_b128 v[120:123], v164 offset:23552
    ds_read_b128 v[140:143], v165 offset:24288
    ds_read_b128 v[144:147], v166 offset:24288
    v_exp_f32 v84, v84
    v_cvt_pk_bf16_f32 v111, v82, v83
    v_exp_f32 v85, v85
    v_exp_f32 v86, v86
    v_exp_f32 v87, v87
    v_mfma_f32_32x32x16_bf16 v[44:59], v[156:159], v[108:111], v[44:59]
    v_cvt_pk_bf16_f32 v112, v84, v85
    v_exp_f32 v88, v88
    v_exp_f32 v89, v89
    v_cvt_pk_bf16_f32 v113, v86, v87
    v_exp_f32 v90, v90
    v_exp_f32 v91, v91
    v_cvt_pk_bf16_f32 v114, v88, v89
    v_cvt_pk_bf16_f32 v115, v90, v91
    s_waitcnt lgkmcnt(3)
    v_mfma_f32_32x32x16_bf16 v[76:91], v[116:119], v[4:7], v[12:27]
    v_exp_f32 v92, v92
    v_exp_f32 v93, v93
    v_exp_f32 v94, v94
    v_exp_f32 v95, v95
    v_cvt_pk_bf16_f32 v108, v92, v93
    v_exp_f32 v96, v96
    v_exp_f32 v97, v97
    v_cvt_pk_bf16_f32 v109, v94, v95
    v_mfma_f32_32x32x16_bf16 v[44:59], v[160:163], v[112:115], v[44:59]
    v_exp_f32 v98, v98
    v_exp_f32 v99, v99
    v_cvt_pk_bf16_f32 v110, v96, v97
    v_exp_f32 v100, v100
    v_cvt_pk_bf16_f32 v111, v98, v99
    v_exp_f32 v101, v101
    v_exp_f32 v102, v102
    v_exp_f32 v103, v103
    v_mfma_f32_32x32x16_bf16 v[60:75], v[156:159], v[108:111], v[60:75]
    v_cvt_pk_bf16_f32 v112, v100, v101
    v_exp_f32 v104, v104
    v_exp_f32 v105, v105
    v_cvt_pk_bf16_f32 v113, v102, v103
    v_exp_f32 v106, v106
    v_exp_f32 v107, v107
    v_cvt_pk_bf16_f32 v114, v104, v105
    v_cvt_pk_bf16_f32 v115, v106, v107
    v_mfma_f32_32x32x16_bf16 v[92:107], v[116:119], v[8:11], v[28:43]
    v_exp_f32 v76, v76
    v_exp_f32 v77, v77
    v_exp_f32 v78, v78
    v_exp_f32 v79, v79
    v_cvt_pk_bf16_f32 v108, v76, v77
    v_exp_f32 v80, v80
    v_exp_f32 v81, v81
    v_cvt_pk_bf16_f32 v109, v78, v79
    v_mfma_f32_32x32x16_bf16 v[60:75], v[160:163], v[112:115], v[60:75]
    v_exp_f32 v82, v82
    v_exp_f32 v83, v83
    v_cvt_pk_bf16_f32 v110, v80, v81
    ds_read_b128 v[124:127], v164 offset:24576
    ds_read_b128 v[148:151], v165 offset:25344
    ds_read_b128 v[152:155], v166 offset:25344
    v_exp_f32 v84, v84
    v_cvt_pk_bf16_f32 v111, v82, v83
    v_exp_f32 v85, v85
    v_exp_f32 v86, v86
    v_exp_f32 v87, v87
    v_mfma_f32_32x32x16_bf16 v[44:59], v[132:135], v[108:111], v[44:59]
    v_cvt_pk_bf16_f32 v112, v84, v85
    v_exp_f32 v88, v88
    v_exp_f32 v89, v89
    v_cvt_pk_bf16_f32 v113, v86, v87
    v_exp_f32 v90, v90
    v_exp_f32 v91, v91
    v_cvt_pk_bf16_f32 v114, v88, v89
    v_cvt_pk_bf16_f32 v115, v90, v91
    s_waitcnt lgkmcnt(3)
    v_mfma_f32_32x32x16_bf16 v[76:91], v[120:123], v[4:7], v[12:27]
    v_exp_f32 v92, v92
    v_exp_f32 v93, v93
    v_exp_f32 v94, v94
    v_exp_f32 v95, v95
    v_cvt_pk_bf16_f32 v108, v92, v93
    v_exp_f32 v96, v96
    v_exp_f32 v97, v97
    v_cvt_pk_bf16_f32 v109, v94, v95
    v_mfma_f32_32x32x16_bf16 v[44:59], v[136:139], v[112:115], v[44:59]
    v_exp_f32 v98, v98
    v_exp_f32 v99, v99
    v_cvt_pk_bf16_f32 v110, v96, v97
    v_exp_f32 v100, v100
    v_cvt_pk_bf16_f32 v111, v98, v99
    v_exp_f32 v101, v101
    v_exp_f32 v102, v102
    v_exp_f32 v103, v103
    v_mfma_f32_32x32x16_bf16 v[60:75], v[132:135], v[108:111], v[60:75]
    v_cvt_pk_bf16_f32 v112, v100, v101
    v_exp_f32 v104, v104
    v_exp_f32 v105, v105
    v_cvt_pk_bf16_f32 v113, v102, v103
    v_exp_f32 v106, v106
    v_exp_f32 v107, v107
    v_cvt_pk_bf16_f32 v114, v104, v105
    v_cvt_pk_bf16_f32 v115, v106, v107
    v_mfma_f32_32x32x16_bf16 v[92:107], v[120:123], v[8:11], v[28:43]
    v_exp_f32 v76, v76
    v_exp_f32 v77, v77
    v_exp_f32 v78, v78
    v_exp_f32 v79, v79
    v_cvt_pk_bf16_f32 v108, v76, v77
    v_exp_f32 v80, v80
    v_exp_f32 v81, v81
    v_cvt_pk_bf16_f32 v109, v78, v79
    v_mfma_f32_32x32x16_bf16 v[60:75], v[136:139], v[112:115], v[60:75]
    v_exp_f32 v82, v82
    v_exp_f32 v83, v83
    v_cvt_pk_bf16_f32 v110, v80, v81
    ds_read_b128 v[128:131], v164 offset:25600
    ds_read_b128 v[156:159], v165 offset:26400
    ds_read_b128 v[160:163], v166 offset:26400
    v_exp_f32 v84, v84
    v_cvt_pk_bf16_f32 v111, v82, v83
    v_exp_f32 v85, v85
    v_exp_f32 v86, v86
    v_exp_f32 v87, v87
    v_mfma_f32_32x32x16_bf16 v[44:59], v[140:143], v[108:111], v[44:59]
    v_cvt_pk_bf16_f32 v112, v84, v85
    v_exp_f32 v88, v88
    v_exp_f32 v89, v89
    v_cvt_pk_bf16_f32 v113, v86, v87
    v_exp_f32 v90, v90
    v_exp_f32 v91, v91
    v_cvt_pk_bf16_f32 v114, v88, v89
    v_cvt_pk_bf16_f32 v115, v90, v91
    s_waitcnt lgkmcnt(3)
    v_mfma_f32_32x32x16_bf16 v[76:91], v[124:127], v[4:7], v[12:27]
    v_exp_f32 v92, v92
    v_exp_f32 v93, v93
    v_exp_f32 v94, v94
    v_exp_f32 v95, v95
    v_cvt_pk_bf16_f32 v108, v92, v93
    v_exp_f32 v96, v96
    v_exp_f32 v97, v97
    v_cvt_pk_bf16_f32 v109, v94, v95
    v_mfma_f32_32x32x16_bf16 v[44:59], v[144:147], v[112:115], v[44:59]
    v_exp_f32 v98, v98
    v_exp_f32 v99, v99
    v_cvt_pk_bf16_f32 v110, v96, v97
    v_exp_f32 v100, v100
    v_cvt_pk_bf16_f32 v111, v98, v99
    v_exp_f32 v101, v101
    v_exp_f32 v102, v102
    v_exp_f32 v103, v103
    v_mfma_f32_32x32x16_bf16 v[60:75], v[140:143], v[108:111], v[60:75]
    v_cvt_pk_bf16_f32 v112, v100, v101
    v_exp_f32 v104, v104
    v_exp_f32 v105, v105
    v_cvt_pk_bf16_f32 v113, v102, v103
    v_exp_f32 v106, v106
    v_exp_f32 v107, v107
    v_cvt_pk_bf16_f32 v114, v104, v105
    v_cvt_pk_bf16_f32 v115, v106, v107
    v_mfma_f32_32x32x16_bf16 v[92:107], v[124:127], v[8:11], v[28:43]
    v_exp_f32 v76, v76
    v_exp_f32 v77, v77
    v_exp_f32 v78, v78
    v_exp_f32 v79, v79
    v_cvt_pk_bf16_f32 v108, v76, v77
    v_exp_f32 v80, v80
    v_exp_f32 v81, v81
    v_cvt_pk_bf16_f32 v109, v78, v79
    v_mfma_f32_32x32x16_bf16 v[60:75], v[144:147], v[112:115], v[60:75]
    v_exp_f32 v82, v82
    v_exp_f32 v83, v83
    v_cvt_pk_bf16_f32 v110, v80, v81
    v_exp_f32 v84, v84
    v_cvt_pk_bf16_f32 v111, v82, v83
    v_exp_f32 v85, v85
    v_exp_f32 v86, v86
    v_exp_f32 v87, v87
    v_mfma_f32_32x32x16_bf16 v[44:59], v[148:151], v[108:111], v[44:59]
    v_cvt_pk_bf16_f32 v112, v84, v85
    v_exp_f32 v88, v88
    v_exp_f32 v89, v89
    v_cvt_pk_bf16_f32 v113, v86, v87
    v_exp_f32 v90, v90
    v_exp_f32 v91, v91
    v_cvt_pk_bf16_f32 v114, v88, v89
    v_cvt_pk_bf16_f32 v115, v90, v91
    s_waitcnt lgkmcnt(0)
    v_mfma_f32_32x32x16_bf16 v[76:91], v[128:131], v[4:7], v[12:27]
    v_exp_f32 v92, v92
    v_exp_f32 v93, v93
    v_exp_f32 v94, v94
    v_exp_f32 v95, v95
    v_cvt_pk_bf16_f32 v108, v92, v93
    v_exp_f32 v96, v96
    v_exp_f32 v97, v97
    v_cvt_pk_bf16_f32 v109, v94, v95
    v_mfma_f32_32x32x16_bf16 v[44:59], v[152:155], v[112:115], v[44:59]
    v_exp_f32 v98, v98
    v_exp_f32 v99, v99
    v_cvt_pk_bf16_f32 v110, v96, v97
    v_exp_f32 v100, v100
    v_cvt_pk_bf16_f32 v111, v98, v99
    v_exp_f32 v101, v101
    v_exp_f32 v102, v102
    v_exp_f32 v103, v103
    v_mfma_f32_32x32x16_bf16 v[60:75], v[148:151], v[108:111], v[60:75]
    v_cvt_pk_bf16_f32 v112, v100, v101
    v_exp_f32 v104, v104
    v_exp_f32 v105, v105
    v_cvt_pk_bf16_f32 v113, v102, v103
    v_exp_f32 v106, v106
    v_exp_f32 v107, v107
    v_cvt_pk_bf16_f32 v114, v104, v105
    v_cvt_pk_bf16_f32 v115, v106, v107
    v_mfma_f32_32x32x16_bf16 v[92:107], v[128:131], v[8:11], v[28:43]
    v_exp_f32 v76, v76
    v_exp_f32 v77, v77
    v_exp_f32 v78, v78
    v_exp_f32 v79, v79
    v_cvt_pk_bf16_f32 v108, v76, v77
    v_exp_f32 v80, v80
    v_exp_f32 v81, v81
    v_cvt_pk_bf16_f32 v109, v78, v79
    v_mfma_f32_32x32x16_bf16 v[60:75], v[152:155], v[112:115], v[60:75]
    v_exp_f32 v82, v82
    v_exp_f32 v83, v83
    v_cvt_pk_bf16_f32 v110, v80, v81
    v_exp_f32 v84, v84
    v_cvt_pk_bf16_f32 v111, v82, v83
    v_exp_f32 v85, v85
    v_exp_f32 v86, v86
    v_exp_f32 v87, v87
    v_mfma_f32_32x32x16_bf16 v[44:59], v[156:159], v[108:111], v[44:59]
    v_cvt_pk_bf16_f32 v112, v84, v85
    v_exp_f32 v88, v88
    v_exp_f32 v89, v89
    v_cvt_pk_bf16_f32 v113, v86, v87
    v_exp_f32 v90, v90
    v_exp_f32 v91, v91
    v_cvt_pk_bf16_f32 v114, v88, v89
    v_cvt_pk_bf16_f32 v115, v90, v91
    s_waitcnt lgkmcnt(0)
    v_exp_f32 v92, v92
    v_exp_f32 v93, v93
    v_exp_f32 v94, v94
    v_exp_f32 v95, v95
    v_cvt_pk_bf16_f32 v108, v92, v93
    v_exp_f32 v96, v96
    v_exp_f32 v97, v97
    v_cvt_pk_bf16_f32 v109, v94, v95
    v_mfma_f32_32x32x16_bf16 v[44:59], v[160:163], v[112:115], v[44:59]
    v_exp_f32 v98, v98
    v_exp_f32 v99, v99
    v_cvt_pk_bf16_f32 v110, v96, v97
    v_exp_f32 v100, v100
    v_cvt_pk_bf16_f32 v111, v98, v99
    v_exp_f32 v101, v101
    v_exp_f32 v102, v102
    v_exp_f32 v103, v103
    v_mfma_f32_32x32x16_bf16 v[60:75], v[156:159], v[108:111], v[60:75]
    v_cvt_pk_bf16_f32 v112, v100, v101
    v_exp_f32 v104, v104
    v_exp_f32 v105, v105
    v_cvt_pk_bf16_f32 v113, v102, v103
    v_exp_f32 v106, v106
    v_exp_f32 v107, v107
    v_cvt_pk_bf16_f32 v114, v104, v105
    v_cvt_pk_bf16_f32 v115, v106, v107
    s_nop 1
    v_mfma_f32_32x32x16_bf16 v[60:75], v[160:163], v[112:115], v[60:75]
    s_xor_b32 s37, s22, 4
    s_mul_i32 s37, s37, 3072
    s_add_u32 s37, s37, 134400
    v_add_u32 v165, s37, v2
    s_mul_i32 s38, s22, 3072
    s_add_u32 s38, s38, 134400
    v_add_u32 v166, s38, v2
    s_lshl_b32 s39, s27, 5
    s_add_u32 s39, s39, s20
    s_lshl_b32 s39, s39, 10
    s_add_u32 s39, s39, 11534336
    s_nop 3
    ds_write_b128 v165, v[60:63]
    ds_write_b128 v165, v[64:67] offset:1024
    ds_write_b32 v165, v68 offset:2048
    s_waitcnt lgkmcnt(0)
    s_barrier
    ds_read_b128 v[92:95], v166
    ds_read_b128 v[96:99], v166 offset:1024
    ds_read_b32 v100, v166 offset:2048
    s_mov_b32 s40, 0x5f800000
    s_waitcnt lgkmcnt(0)
    v_add_f32 v52, v52, v100
    v_add_f32 v44, v44, v92
    v_add_f32 v45, v45, v93
    v_add_f32 v46, v46, v94
    v_add_f32 v47, v47, v95
    v_add_f32 v48, v48, v96
    v_add_f32 v49, v49, v97
    v_add_f32 v50, v50, v98
    v_add_f32 v51, v51, v99
    v_cmp_gt_f32 vcc, s40, v52
    s_nop 1
    s_cmp_eq_u64 vcc, exec
    s_cbranch_scc0 K3_SLOW
K3_FIN:
    v_rcp_f32 v165, v52
    s_nop 0
    v_mul_f32 v44, v44, v165
    v_mul_f32 v45, v45, v165
    v_mul_f32 v46, v46, v165
    v_mul_f32 v47, v47, v165
    v_mul_f32 v48, v48, v165
    v_mul_f32 v49, v49, v165
    v_mul_f32 v50, v50, v165
    v_mul_f32 v51, v51, v165
    v_cvt_pk_bf16_f32 v108, v44, v45
    v_cvt_pk_bf16_f32 v109, v46, v47
    v_cvt_pk_bf16_f32 v110, v48, v49
    v_cvt_pk_bf16_f32 v111, v50, v51
    v_min_u32 v108, 0xfffffffe, v108
    v_min_u32 v109, 0xfffffffe, v109
    v_min_u32 v110, 0xfffffffe, v110
    v_min_u32 v111, 0xfffffffe, v111
    buffer_store_dwordx4 v[108:111], v2, s[8:11], s39 offen sc1
    s_and_b32 s40, s2, 7
    s_lshl_b32 s40, s40, 2
    s_bfe_u32 s41, s2, 0x20003
    s_add_u32 s40, s40, s41
    s_lshr_b32 s41, s2, 5
    s_and_b32 s24, s22, 1
    s_bfe_u32 s23, s22, 0x10001
    s_cmp_lt_u32 s22, 4
    s_cbranch_scc1 K4_CONS
    s_lshl_b32 s25, s40, 1
    s_add_u32 s25, s25, s24
    s_lshl_b32 s25, s25, 15
    s_lshl_b32 s26, s23, 11
    s_add_u32 s25, s25, s26
    s_add_u32 s25, s25, 11534336
    s_lshl_b32 s27, s24, 15
    s_add_u32 s26, s26, s27
    s_add_u32 s26, s26, 0
    v_and_b32 v4, 15, v1
    v_lshrrev_b32 v5, 1, v4
    v_lshlrev_b32 v5, 12, v5
    v_and_b32 v4, 1, v4
    v_lshl_add_u32 v5, v4, 10, v5
    s_mov_b32 s28, 0
    s_mov_b64 exec, 0xffff
    s_waitcnt vmcnt(0)
K4_POLL:
    buffer_load_dword v6, v5, s[8:11], s25 offen offset:1020 sc1
    s_add_u32 s28, s28, 1
    s_waitcnt vmcnt(0)
    v_cmp_eq_u32 vcc, -1, v6
    s_cmp_gt_u32 s28, 0x100000
    s_cbranch_scc1 K4_PX
    s_and_b64 exec, exec, vcc
    s_cbranch_execnz K4_POLL
K4_PX:
    s_mov_b64 exec, -1
    s_add_u32 m0, s26, 0
    s_add_u32 s27, s25, 0
    buffer_load_dwordx4 v2, s[8:11], s27 offen offset:0  lds
    buffer_load_dwordx4 v2, s[8:11], s27 offen offset:1024  lds
    s_add_u32 m0, s26, 4096
    s_add_u32 s27, s25, 4096
    buffer_load_dwordx4 v2, s[8:11], s27 offen offset:0  lds
    buffer_load_dwordx4 v2, s[8:11], s27 offen offset:1024  lds
    s_add_u32 m0, s26, 8192
    s_add_u32 s27, s25, 8192
    buffer_load_dwordx4 v2, s[8:11], s27 offen offset:0  lds
    buffer_load_dwordx4 v2, s[8:11], s27 offen offset:1024  lds
    s_add_u32 m0, s26, 12288
    s_add_u32 s27, s25, 12288
    buffer_load_dwordx4 v2, s[8:11], s27 offen offset:0  lds
    buffer_load_dwordx4 v2, s[8:11], s27 offen offset:1024  lds
    s_add_u32 m0, s26, 16384
    s_add_u32 s27, s25, 16384
    buffer_load_dwordx4 v2, s[8:11], s27 offen offset:0  lds
    buffer_load_dwordx4 v2, s[8:11], s27 offen offset:1024  lds
    s_add_u32 m0, s26, 20480
    s_add_u32 s27, s25, 20480
    buffer_load_dwordx4 v2, s[8:11], s27 offen offset:0  lds
    buffer_load_dwordx4 v2, s[8:11], s27 offen offset:1024  lds
    s_add_u32 m0, s26, 24576
    s_add_u32 s27, s25, 24576
    buffer_load_dwordx4 v2, s[8:11], s27 offen offset:0  lds
    buffer_load_dwordx4 v2, s[8:11], s27 offen offset:1024  lds
    s_add_u32 m0, s26, 28672
    s_add_u32 s27, s25, 28672
    buffer_load_dwordx4 v2, s[8:11], s27 offen offset:0  lds
    buffer_load_dwordx4 v2, s[8:11], s27 offen offset:1024  lds
    s_waitcnt vmcnt(14)
    s_barrier
    s_waitcnt vmcnt(12)
    s_barrier
    s_waitcnt vmcnt(10)
    s_barrier
    s_waitcnt vmcnt(8)
    s_barrier
    s_waitcnt vmcnt(6)
    s_barrier
    s_waitcnt vmcnt(4)
    s_barrier
    s_waitcnt vmcnt(2)
    s_barrier
    s_waitcnt vmcnt(0)
    s_barrier
    s_endpgm
K4_CONS:
    v_lshrrev_b32 v4, 3, v1
    v_bfe_u32 v5, v1, 4, 1
    v_lshlrev_b32 v5, 2, v5
    v_and_b32 v6, 7, v1
    v_xor_b32 v5, v5, v6
    v_lshlrev_b32 v4, 10, v4
    v_lshl_add_u32 v4, v5, 4, v4
    s_lshl_b32 s25, s41, 7
    s_lshl_b32 s26, s22, 13
    s_add_u32 s25, s25, s26
    s_lshl_b32 s26, s22, 10
    s_add_u32 s26, s26, 65536
    s_add_u32 m0, s26, 0
    s_add_u32 s27, s25, 0
    buffer_load_dwordx4 v4, s[16:19], s27 offen lds
    s_add_u32 m0, s26, 4096
    s_add_u32 s27, s25, 32768
    buffer_load_dwordx4 v4, s[16:19], s27 offen lds
    s_add_u32 m0, s26, 8192
    s_add_u32 s27, s25, 65536
    buffer_load_dwordx4 v4, s[16:19], s27 offen lds
    s_add_u32 m0, s26, 12288
    s_add_u32 s27, s25, 98304
    buffer_load_dwordx4 v4, s[16:19], s27 offen lds
    s_add_u32 m0, s26, 16384
    s_add_u32 s27, s25, 131072
    buffer_load_dwordx4 v4, s[16:19], s27 offen lds
    s_add_u32 m0, s26, 20480
    s_add_u32 s27, s25, 163840
    buffer_load_dwordx4 v4, s[16:19], s27 offen lds
    s_add_u32 m0, s26, 24576
    s_add_u32 s27, s25, 196608
    buffer_load_dwordx4 v4, s[16:19], s27 offen lds
    s_add_u32 m0, s26, 28672
    s_add_u32 s27, s25, 229376
    buffer_load_dwordx4 v4, s[16:19], s27 offen lds
    s_add_u32 m0, s26, 32768
    s_add_u32 s27, s25, 262144
    buffer_load_dwordx4 v4, s[16:19], s27 offen lds
    s_add_u32 m0, s26, 36864
    s_add_u32 s27, s25, 294912
    buffer_load_dwordx4 v4, s[16:19], s27 offen lds
    s_add_u32 m0, s26, 40960
    s_add_u32 s27, s25, 327680
    buffer_load_dwordx4 v4, s[16:19], s27 offen lds
    s_add_u32 m0, s26, 45056
    s_add_u32 s27, s25, 360448
    buffer_load_dwordx4 v4, s[16:19], s27 offen lds
    s_add_u32 m0, s26, 49152
    s_add_u32 s27, s25, 393216
    buffer_load_dwordx4 v4, s[16:19], s27 offen lds
    s_add_u32 m0, s26, 53248
    s_add_u32 s27, s25, 425984
    buffer_load_dwordx4 v4, s[16:19], s27 offen lds
    s_add_u32 m0, s26, 57344
    s_add_u32 s27, s25, 458752
    buffer_load_dwordx4 v4, s[16:19], s27 offen lds
    s_add_u32 m0, s26, 61440
    s_add_u32 s27, s25, 491520
    buffer_load_dwordx4 v4, s[16:19], s27 offen lds
    s_lshl_b32 s25, s40, 1
    s_add_u32 s25, s25, s23
    s_lshl_b32 s29, s41, 1
    s_add_u32 s29, s29, s24
    v_and_b32 v4, 31, v1
    v_lshrrev_b32 v5, 5, v1
    v_lshlrev_b32 v6, 10, v4
    v_lshl_add_u32 v6, v5, 5, v6
    s_lshl_b32 s32, s25, 15
    s_lshl_b32 s33, s29, 6
    s_add_u32 s32, s32, s33
    s_add_u32 s33, s32, 13631488
    buffer_load_dwordx4 v[32:35], v6, s[12:15], s32 offen
    buffer_load_dwordx4 v[36:39], v6, s[12:15], s32 offen offset:16
    s_lshl_b32 s36, s24, 7
    s_add_u32 s36, s36, 133120
    v_lshlrev_b32 v11, 6, v5
    v_add_u32 v11, s36, v11
    ds_read_b128 v[40:43], v11 offset:0
    ds_read_b128 v[56:59], v11 offset:256
    ds_read_b128 v[44:47], v11 offset:16
    ds_read_b128 v[60:63], v11 offset:272
    ds_read_b128 v[48:51], v11 offset:32
    ds_read_b128 v[64:67], v11 offset:288
    ds_read_b128 v[52:55], v11 offset:48
    ds_read_b128 v[68:71], v11 offset:304
    s_lshl_b32 s36, s23, 15
    s_add_u32 s36, s36, 0
    v_add_u32 v3, s36, v2
    v_lshlrev_b32 v14, 9, v5
    v_bfe_u32 v15, v1, 2, 2
    v_lshl_add_u32 v14, v15, 7, v14
    v_bfe_u32 v15, v1, 3, 1
    v_xor_b32 v15, s24, v15
    v_lshl_add_u32 v14, v15, 6, v14
    v_and_b32 v15, 1, v1
    v_lshl_add_u32 v14, v15, 5, v14
    v_bfe_u32 v15, v1, 4, 1
    v_lshl_add_u32 v14, v15, 4, v14
    v_bfe_u32 v15, v1, 1, 1
    v_lshl_add_u32 v14, v15, 3, v14
    v_add_u32 v14, 65536, v14
    v_lshlrev_b32 v12, 2, v4
    v_lshl_add_u32 v12, v5, 13, v12
    s_lshl_b32 s38, s25, 7
    s_add_u32 s38, s38, 16384
    s_add_u32 s39, s38, 16384
    v_mov_b32 v13, 0
    s_waitcnt vmcnt(0) lgkmcnt(0)
    v_lshlrev_b32 v72, 16, v32
    v_and_b32 v73, 0xffff0000, v32
    v_lshlrev_b32 v74, 16, v33
    v_and_b32 v75, 0xffff0000, v33
    v_lshlrev_b32 v76, 16, v34
    v_and_b32 v77, 0xffff0000, v34
    v_lshlrev_b32 v78, 16, v35
    v_and_b32 v79, 0xffff0000, v35
    v_lshlrev_b32 v80, 16, v36
    v_and_b32 v81, 0xffff0000, v36
    v_lshlrev_b32 v82, 16, v37
    v_and_b32 v83, 0xffff0000, v37
    v_lshlrev_b32 v84, 16, v38
    v_and_b32 v85, 0xffff0000, v38
    v_lshlrev_b32 v86, 16, v39
    v_and_b32 v87, 0xffff0000, v39
    s_waitcnt lgkmcnt(0)
    s_barrier
    ds_read_b64_tr_b16 v[100:101], v14 offset:0
    ds_read_b64_tr_b16 v[102:103], v14 offset:1024
    ds_read_b64_tr_b16 v[108:109], v14 offset:2048
    ds_read_b64_tr_b16 v[110:111], v14 offset:3072
    ds_read_b64_tr_b16 v[116:117], v14 offset:4096
    ds_read_b64_tr_b16 v[118:119], v14 offset:5120
    ds_read_b64_tr_b16 v[124:125], v14 offset:6144
    ds_read_b64_tr_b16 v[126:127], v14 offset:7168
    ds_read_b128 v[96:99], v3 offset:0
    ds_read_b128 v[104:107], v3 offset:1024
    ds_read_b128 v[112:115], v3 offset:2048
    ds_read_b128 v[120:123], v3 offset:3072
    s_waitcnt lgkmcnt(0)
    ds_read_b64_tr_b16 v[132:133], v14 offset:8192
    ds_read_b64_tr_b16 v[134:135], v14 offset:9216
    ds_read_b64_tr_b16 v[140:141], v14 offset:10240
    ds_read_b64_tr_b16 v[142:143], v14 offset:11264
    ds_read_b64_tr_b16 v[148:149], v14 offset:12288
    ds_read_b64_tr_b16 v[150:151], v14 offset:13312
    ds_read_b64_tr_b16 v[156:157], v14 offset:14336
    ds_read_b64_tr_b16 v[158:159], v14 offset:15360
    s_barrier
    ds_read_b128 v[128:131], v3 offset:4096
    ds_read_b128 v[136:139], v3 offset:5120
    ds_read_b128 v[144:147], v3 offset:6144
    ds_read_b128 v[152:155], v3 offset:7168
    v_mfma_f32_32x32x16_bf16 v[16:31], v[100:103], v[96:99], 0
    v_max3_u32 v13, v13, v96, v97
    v_max3_u32 v13, v13, v98, v99
    v_mfma_f32_32x32x16_bf16 v[16:31], v[108:111], v[104:107], v[16:31]
    v_max3_u32 v13, v13, v104, v105
    v_max3_u32 v13, v13, v106, v107
    v_mfma_f32_32x32x16_bf16 v[16:31], v[116:119], v[112:115], v[16:31]
    v_max3_u32 v13, v13, v112, v113
    v_max3_u32 v13, v13, v114, v115
    v_mfma_f32_32x32x16_bf16 v[16:31], v[124:127], v[120:123], v[16:31]
    v_max3_u32 v13, v13, v120, v121
    v_max3_u32 v13, v13, v122, v123
    s_waitcnt lgkmcnt(0)
    ds_read_b64_tr_b16 v[100:101], v14 offset:16384
    ds_read_b64_tr_b16 v[102:103], v14 offset:17408
    ds_read_b64_tr_b16 v[108:109], v14 offset:18432
    ds_read_b64_tr_b16 v[110:111], v14 offset:19456
    ds_read_b64_tr_b16 v[116:117], v14 offset:20480
    ds_read_b64_tr_b16 v[118:119], v14 offset:21504
    ds_read_b64_tr_b16 v[124:125], v14 offset:22528
    ds_read_b64_tr_b16 v[126:127], v14 offset:23552
    s_barrier
    ds_read_b128 v[96:99], v3 offset:8192
    ds_read_b128 v[104:107], v3 offset:9216
    ds_read_b128 v[112:115], v3 offset:10240
    ds_read_b128 v[120:123], v3 offset:11264
    v_mfma_f32_32x32x16_bf16 v[16:31], v[132:135], v[128:131], v[16:31]
    v_max3_u32 v13, v13, v128, v129
    v_max3_u32 v13, v13, v130, v131
    v_mfma_f32_32x32x16_bf16 v[16:31], v[140:143], v[136:139], v[16:31]
    v_max3_u32 v13, v13, v136, v137
    v_max3_u32 v13, v13, v138, v139
    v_mfma_f32_32x32x16_bf16 v[16:31], v[148:151], v[144:147], v[16:31]
    v_max3_u32 v13, v13, v144, v145
    v_max3_u32 v13, v13, v146, v147
    v_mfma_f32_32x32x16_bf16 v[16:31], v[156:159], v[152:155], v[16:31]
    v_max3_u32 v13, v13, v152, v153
    v_max3_u32 v13, v13, v154, v155
    s_waitcnt lgkmcnt(0)
    ds_read_b64_tr_b16 v[132:133], v14 offset:24576
    ds_read_b64_tr_b16 v[134:135], v14 offset:25600
    ds_read_b64_tr_b16 v[140:141], v14 offset:26624
    ds_read_b64_tr_b16 v[142:143], v14 offset:27648
    ds_read_b64_tr_b16 v[148:149], v14 offset:28672
    ds_read_b64_tr_b16 v[150:151], v14 offset:29696
    ds_read_b64_tr_b16 v[156:157], v14 offset:30720
    ds_read_b64_tr_b16 v[158:159], v14 offset:31744
    s_barrier
    ds_read_b128 v[128:131], v3 offset:12288
    ds_read_b128 v[136:139], v3 offset:13312
    ds_read_b128 v[144:147], v3 offset:14336
    ds_read_b128 v[152:155], v3 offset:15360
    v_mfma_f32_32x32x16_bf16 v[16:31], v[100:103], v[96:99], v[16:31]
    v_max3_u32 v13, v13, v96, v97
    v_max3_u32 v13, v13, v98, v99
    v_mfma_f32_32x32x16_bf16 v[16:31], v[108:111], v[104:107], v[16:31]
    v_max3_u32 v13, v13, v104, v105
    v_max3_u32 v13, v13, v106, v107
    v_mfma_f32_32x32x16_bf16 v[16:31], v[116:119], v[112:115], v[16:31]
    v_max3_u32 v13, v13, v112, v113
    v_max3_u32 v13, v13, v114, v115
    v_mfma_f32_32x32x16_bf16 v[16:31], v[124:127], v[120:123], v[16:31]
    v_max3_u32 v13, v13, v120, v121
    v_max3_u32 v13, v13, v122, v123
    s_waitcnt lgkmcnt(0)
    ds_read_b64_tr_b16 v[100:101], v14 offset:32768
    ds_read_b64_tr_b16 v[102:103], v14 offset:33792
    ds_read_b64_tr_b16 v[108:109], v14 offset:34816
    ds_read_b64_tr_b16 v[110:111], v14 offset:35840
    ds_read_b64_tr_b16 v[116:117], v14 offset:36864
    ds_read_b64_tr_b16 v[118:119], v14 offset:37888
    ds_read_b64_tr_b16 v[124:125], v14 offset:38912
    ds_read_b64_tr_b16 v[126:127], v14 offset:39936
    s_barrier
    ds_read_b128 v[96:99], v3 offset:16384
    ds_read_b128 v[104:107], v3 offset:17408
    ds_read_b128 v[112:115], v3 offset:18432
    ds_read_b128 v[120:123], v3 offset:19456
    v_mfma_f32_32x32x16_bf16 v[16:31], v[132:135], v[128:131], v[16:31]
    v_max3_u32 v13, v13, v128, v129
    v_max3_u32 v13, v13, v130, v131
    v_mfma_f32_32x32x16_bf16 v[16:31], v[140:143], v[136:139], v[16:31]
    v_max3_u32 v13, v13, v136, v137
    v_max3_u32 v13, v13, v138, v139
    v_mfma_f32_32x32x16_bf16 v[16:31], v[148:151], v[144:147], v[16:31]
    v_max3_u32 v13, v13, v144, v145
    v_max3_u32 v13, v13, v146, v147
    v_mfma_f32_32x32x16_bf16 v[16:31], v[156:159], v[152:155], v[16:31]
    v_max3_u32 v13, v13, v152, v153
    v_max3_u32 v13, v13, v154, v155
    s_waitcnt lgkmcnt(0)
    ds_read_b64_tr_b16 v[132:133], v14 offset:40960
    ds_read_b64_tr_b16 v[134:135], v14 offset:41984
    ds_read_b64_tr_b16 v[140:141], v14 offset:43008
    ds_read_b64_tr_b16 v[142:143], v14 offset:44032
    ds_read_b64_tr_b16 v[148:149], v14 offset:45056
    ds_read_b64_tr_b16 v[150:151], v14 offset:46080
    ds_read_b64_tr_b16 v[156:157], v14 offset:47104
    ds_read_b64_tr_b16 v[158:159], v14 offset:48128
    s_barrier
    ds_read_b128 v[128:131], v3 offset:20480
    ds_read_b128 v[136:139], v3 offset:21504
    ds_read_b128 v[144:147], v3 offset:22528
    ds_read_b128 v[152:155], v3 offset:23552
    v_mfma_f32_32x32x16_bf16 v[16:31], v[100:103], v[96:99], v[16:31]
    v_max3_u32 v13, v13, v96, v97
    v_max3_u32 v13, v13, v98, v99
    v_mfma_f32_32x32x16_bf16 v[16:31], v[108:111], v[104:107], v[16:31]
    v_max3_u32 v13, v13, v104, v105
    v_max3_u32 v13, v13, v106, v107
    v_mfma_f32_32x32x16_bf16 v[16:31], v[116:119], v[112:115], v[16:31]
    v_max3_u32 v13, v13, v112, v113
    v_max3_u32 v13, v13, v114, v115
    v_mfma_f32_32x32x16_bf16 v[16:31], v[124:127], v[120:123], v[16:31]
    v_max3_u32 v13, v13, v120, v121
    v_max3_u32 v13, v13, v122, v123
    s_waitcnt lgkmcnt(0)
    ds_read_b64_tr_b16 v[100:101], v14 offset:49152
    ds_read_b64_tr_b16 v[102:103], v14 offset:50176
    ds_read_b64_tr_b16 v[108:109], v14 offset:51200
    ds_read_b64_tr_b16 v[110:111], v14 offset:52224
    ds_read_b64_tr_b16 v[116:117], v14 offset:53248
    ds_read_b64_tr_b16 v[118:119], v14 offset:54272
    ds_read_b64_tr_b16 v[124:125], v14 offset:55296
    ds_read_b64_tr_b16 v[126:127], v14 offset:56320
    s_barrier
    ds_read_b128 v[96:99], v3 offset:24576
    ds_read_b128 v[104:107], v3 offset:25600
    ds_read_b128 v[112:115], v3 offset:26624
    ds_read_b128 v[120:123], v3 offset:27648
    v_mfma_f32_32x32x16_bf16 v[16:31], v[132:135], v[128:131], v[16:31]
    v_max3_u32 v13, v13, v128, v129
    v_max3_u32 v13, v13, v130, v131
    v_mfma_f32_32x32x16_bf16 v[16:31], v[140:143], v[136:139], v[16:31]
    v_max3_u32 v13, v13, v136, v137
    v_max3_u32 v13, v13, v138, v139
    v_mfma_f32_32x32x16_bf16 v[16:31], v[148:151], v[144:147], v[16:31]
    v_max3_u32 v13, v13, v144, v145
    v_max3_u32 v13, v13, v146, v147
    v_mfma_f32_32x32x16_bf16 v[16:31], v[156:159], v[152:155], v[16:31]
    v_max3_u32 v13, v13, v152, v153
    v_max3_u32 v13, v13, v154, v155
    s_waitcnt lgkmcnt(0)
    ds_read_b64_tr_b16 v[132:133], v14 offset:57344
    ds_read_b64_tr_b16 v[134:135], v14 offset:58368
    ds_read_b64_tr_b16 v[140:141], v14 offset:59392
    ds_read_b64_tr_b16 v[142:143], v14 offset:60416
    ds_read_b64_tr_b16 v[148:149], v14 offset:61440
    ds_read_b64_tr_b16 v[150:151], v14 offset:62464
    ds_read_b64_tr_b16 v[156:157], v14 offset:63488
    ds_read_b64_tr_b16 v[158:159], v14 offset:64512
    s_barrier
    ds_read_b128 v[128:131], v3 offset:28672
    ds_read_b128 v[136:139], v3 offset:29696
    ds_read_b128 v[144:147], v3 offset:30720
    ds_read_b128 v[152:155], v3 offset:31744
    v_mfma_f32_32x32x16_bf16 v[16:31], v[100:103], v[96:99], v[16:31]
    v_max3_u32 v13, v13, v96, v97
    v_max3_u32 v13, v13, v98, v99
    v_mfma_f32_32x32x16_bf16 v[16:31], v[108:111], v[104:107], v[16:31]
    v_max3_u32 v13, v13, v104, v105
    v_max3_u32 v13, v13, v106, v107
    v_mfma_f32_32x32x16_bf16 v[16:31], v[116:119], v[112:115], v[16:31]
    v_max3_u32 v13, v13, v112, v113
    v_max3_u32 v13, v13, v114, v115
    v_mfma_f32_32x32x16_bf16 v[16:31], v[124:127], v[120:123], v[16:31]
    v_max3_u32 v13, v13, v120, v121
    v_max3_u32 v13, v13, v122, v123
    s_waitcnt lgkmcnt(3)
    v_mfma_f32_32x32x16_bf16 v[16:31], v[132:135], v[128:131], v[16:31]
    v_max3_u32 v13, v13, v128, v129
    v_max3_u32 v13, v13, v130, v131
    s_waitcnt lgkmcnt(2)
    v_mfma_f32_32x32x16_bf16 v[16:31], v[140:143], v[136:139], v[16:31]
    v_max3_u32 v13, v13, v136, v137
    v_max3_u32 v13, v13, v138, v139
    s_waitcnt lgkmcnt(1)
    v_mfma_f32_32x32x16_bf16 v[16:31], v[148:151], v[144:147], v[16:31]
    v_max3_u32 v13, v13, v144, v145
    v_max3_u32 v13, v13, v146, v147
    s_waitcnt lgkmcnt(0)
    v_mfma_f32_32x32x16_bf16 v[16:31], v[156:159], v[152:155], v[16:31]
    v_max3_u32 v13, v13, v152, v153
    v_max3_u32 v13, v13, v154, v155
    v_cmp_eq_u32 vcc, -1, v13
    s_nop 8
    s_cbranch_vccnz K4_REDO
K4_EPI:
    v_cvt_pk_bf16_f32 v32, v16, v17
    v_cvt_pk_bf16_f32 v33, v18, v19
    v_cvt_pk_bf16_f32 v34, v20, v21
    v_cvt_pk_bf16_f32 v35, v22, v23
    v_cvt_pk_bf16_f32 v36, v24, v25
    v_cvt_pk_bf16_f32 v37, v26, v27
    v_cvt_pk_bf16_f32 v38, v28, v29
    v_cvt_pk_bf16_f32 v39, v30, v31
    v_lshlrev_b32 v16, 16, v32
    v_and_b32 v17, 0xffff0000, v32
    v_lshlrev_b32 v18, 16, v33
    v_and_b32 v19, 0xffff0000, v33
    v_lshlrev_b32 v20, 16, v34
    v_and_b32 v21, 0xffff0000, v34
    v_lshlrev_b32 v22, 16, v35
    v_and_b32 v23, 0xffff0000, v35
    v_lshlrev_b32 v24, 16, v36
    v_and_b32 v25, 0xffff0000, v36
    v_lshlrev_b32 v26, 16, v37
    v_and_b32 v27, 0xffff0000, v37
    v_lshlrev_b32 v28, 16, v38
    v_and_b32 v29, 0xffff0000, v38
    v_lshlrev_b32 v30, 16, v39
    v_and_b32 v31, 0xffff0000, v39
    v_pk_mul_f32 v[16:17], v[16:17], v[40:41]
    v_pk_mul_f32 v[18:19], v[18:19], v[42:43]
    v_pk_mul_f32 v[20:21], v[20:21], v[44:45]
    v_pk_mul_f32 v[22:23], v[22:23], v[46:47]
    v_pk_mul_f32 v[24:25], v[24:25], v[48:49]
    v_pk_mul_f32 v[26:27], v[26:27], v[50:51]
    v_pk_mul_f32 v[28:29], v[28:29], v[52:53]
    v_pk_mul_f32 v[30:31], v[30:31], v[54:55]
    v_cvt_pk_bf16_f32 v32, v16, v17
    v_cvt_pk_bf16_f32 v33, v18, v19
    v_cvt_pk_bf16_f32 v34, v20, v21
    v_cvt_pk_bf16_f32 v35, v22, v23
    v_cvt_pk_bf16_f32 v36, v24, v25
    v_cvt_pk_bf16_f32 v37, v26, v27
    v_cvt_pk_bf16_f32 v38, v28, v29
    v_cvt_pk_bf16_f32 v39, v30, v31
    v_lshlrev_b32 v16, 16, v32
    v_and_b32 v17, 0xffff0000, v32
    v_lshlrev_b32 v18, 16, v33
    v_and_b32 v19, 0xffff0000, v33
    v_lshlrev_b32 v20, 16, v34
    v_and_b32 v21, 0xffff0000, v34
    v_lshlrev_b32 v22, 16, v35
    v_and_b32 v23, 0xffff0000, v35
    v_lshlrev_b32 v24, 16, v36
    v_and_b32 v25, 0xffff0000, v36
    v_lshlrev_b32 v26, 16, v37
    v_and_b32 v27, 0xffff0000, v37
    v_lshlrev_b32 v28, 16, v38
    v_and_b32 v29, 0xffff0000, v38
    v_lshlrev_b32 v30, 16, v39
    v_and_b32 v31, 0xffff0000, v39
    v_pk_add_f32 v[16:17], v[16:17], v[72:73]
    v_pk_add_f32 v[18:19], v[18:19], v[74:75]
    v_pk_add_f32 v[20:21], v[20:21], v[76:77]
    v_pk_add_f32 v[22:23], v[22:23], v[78:79]
    v_pk_add_f32 v[24:25], v[24:25], v[80:81]
    v_pk_add_f32 v[26:27], v[26:27], v[82:83]
    v_pk_add_f32 v[28:29], v[28:29], v[84:85]
    v_pk_add_f32 v[30:31], v[30:31], v[86:87]
    v_cvt_pk_bf16_f32 v32, v16, v17
    v_cvt_pk_bf16_f32 v33, v18, v19
    v_cvt_pk_bf16_f32 v34, v20, v21
    v_cvt_pk_bf16_f32 v35, v22, v23
    v_cvt_pk_bf16_f32 v36, v24, v25
    v_cvt_pk_bf16_f32 v37, v26, v27
    v_cvt_pk_bf16_f32 v38, v28, v29
    v_cvt_pk_bf16_f32 v39, v30, v31
    buffer_store_dwordx4 v[32:35], v6, s[8:11], s33 offen
    buffer_store_dwordx4 v[36:39], v6, s[8:11], s33 offen offset:16
    s_mov_b32 s40, 0x3f803f80
    v_dot2_f32_bf16 v88, v32, s40, 0
    v_dot2_f32_bf16 v89, v32, v32, 0
    v_lshlrev_b32 v16, 16, v32
    v_and_b32 v17, 0xffff0000, v32
    v_dot2_f32_bf16 v88, v33, s40, v88
    v_dot2_f32_bf16 v89, v33, v33, v89
    v_lshlrev_b32 v18, 16, v33
    v_and_b32 v19, 0xffff0000, v33
    v_dot2_f32_bf16 v88, v34, s40, v88
    v_dot2_f32_bf16 v89, v34, v34, v89
    v_lshlrev_b32 v20, 16, v34
    v_and_b32 v21, 0xffff0000, v34
    v_dot2_f32_bf16 v88, v35, s40, v88
    v_dot2_f32_bf16 v89, v35, v35, v89
    v_lshlrev_b32 v22, 16, v35
    v_and_b32 v23, 0xffff0000, v35
    v_dot2_f32_bf16 v88, v36, s40, v88
    v_dot2_f32_bf16 v89, v36, v36, v89
    v_lshlrev_b32 v24, 16, v36
    v_and_b32 v25, 0xffff0000, v36
    v_dot2_f32_bf16 v88, v37, s40, v88
    v_dot2_f32_bf16 v89, v37, v37, v89
    v_lshlrev_b32 v26, 16, v37
    v_and_b32 v27, 0xffff0000, v37
    v_dot2_f32_bf16 v88, v38, s40, v88
    v_dot2_f32_bf16 v89, v38, v38, v89
    v_lshlrev_b32 v28, 16, v38
    v_and_b32 v29, 0xffff0000, v38
    v_dot2_f32_bf16 v88, v39, s40, v88
    v_dot2_f32_bf16 v89, v39, v39, v89
    v_lshlrev_b32 v30, 16, v39
    v_and_b32 v31, 0xffff0000, v39
    v_pk_mul_f32 v[90:91], v[16:17], v[56:57]
    v_pk_fma_f32 v[90:91], v[18:19], v[58:59], v[90:91]
    v_pk_fma_f32 v[90:91], v[20:21], v[60:61], v[90:91]
    v_pk_fma_f32 v[90:91], v[22:23], v[62:63], v[90:91]
    v_pk_fma_f32 v[90:91], v[24:25], v[64:65], v[90:91]
    v_pk_fma_f32 v[90:91], v[26:27], v[66:67], v[90:91]
    v_pk_fma_f32 v[90:91], v[28:29], v[68:69], v[90:91]
    v_pk_fma_f32 v[90:91], v[30:31], v[70:71], v[90:91]
    v_permlane32_swap_b32 v88, v89
    v_add_f32 v90, v90, v91
    v_add_f32 v88, v88, v89
    v_mov_b32 v91, v90
    buffer_atomic_add_f32 v88, v12, s[8:11], s38 offen
    s_nop 0
    v_permlane32_swap_b32 v90, v91
    v_add_f32 v90, v90, v91
    s_mov_b32 exec_hi, 0
    buffer_atomic_add_f32 v90, v12, s[8:11], s39 offen
    s_endpgm
K4_REDO:
    s_lshl_b32 s36, s25, 15
    s_add_u32 s36, s36, 11534336
    s_mov_b32 s37, 32
    s_mov_b32 s28, 0
    v_mov_b32 v16, 0
    v_mov_b32 v17, 0
    v_mov_b32 v18, 0
    v_mov_b32 v19, 0
    v_mov_b32 v20, 0
    v_mov_b32 v21, 0
    v_mov_b32 v22, 0
    v_mov_b32 v23, 0
    v_mov_b32 v24, 0
    v_mov_b32 v25, 0
    v_mov_b32 v26, 0
    v_mov_b32 v27, 0
    v_mov_b32 v28, 0
    v_mov_b32 v29, 0
    v_mov_b32 v30, 0
    v_mov_b32 v31, 0
K4_RL:
    buffer_load_dwordx4 v[96:99], v2, s[8:11], s36 offen sc1
    ds_read_b64_tr_b16 v[100:101], v14
    ds_read_b64_tr_b16 v[102:103], v14 offset:1024
    s_add_u32 s28, s28, 1
    s_waitcnt vmcnt(0) lgkmcnt(0)
    v_max3_u32 v13, v96, v97, v98
    v_max_u32 v13, v13, v99
    v_cmp_eq_u32 vcc, -1, v13
    s_cmp_gt_u32 s28, 0x100000
    s_cbranch_scc1 K4_RGO
    s_cbranch_vccnz K4_RL
K4_RGO:
    v_mfma_f32_32x32x16_bf16 v[16:31], v[100:103], v[96:99], v[16:31]
    v_add_u32 v14, 2048, v14
    s_add_u32 s36, s36, 1024
    s_sub_u32 s37, s37, 1
    s_nop 12
    s_cmp_lg_u32 s37, 0
    s_cbranch_scc1 K4_RL
    s_branch K4_EPI
K3_END:
    s_endpgm
K3_SLOW:
    s_waitcnt vmcnt(0)
    s_mov_b32 s32, s31
    s_add_u32 s33, s31, 2097152
    s_mov_b32 s36, 64
    v_mov_b32 v44, 0
    v_mov_b32 v45, 0
    v_mov_b32 v46, 0
    v_mov_b32 v47, 0
    v_mov_b32 v48, 0
    v_mov_b32 v49, 0
    v_mov_b32 v50, 0
    v_mov_b32 v51, 0
    v_mov_b32 v52, 0
    v_mov_b32 v53, 0
    v_mov_b32 v54, 0
    v_mov_b32 v55, 0
    v_mov_b32 v56, 0
    v_mov_b32 v57, 0
    v_mov_b32 v58, 0
    v_mov_b32 v59, 0
    v_mov_b32 v164, 0xff7fffff
K3_SLOOP:
    buffer_load_dwordx4 v[116:119], v2, s[8:11], s32 offen offset:0
    s_mov_b64 exec, s[34:35]
    buffer_load_dwordx4 v[132:135], v3, s[8:11], s33 offen offset:0
    buffer_load_dwordx4 v[136:139], v3, s[8:11], s33 offen offset:512
    s_mov_b64 exec, -1
    s_waitcnt vmcnt(0)
    v_mfma_f32_32x32x16_bf16 v[76:91], v[116:119], v[4:7], 0
    s_nop 15
    v_max3_f32 v165, v76, v77, v78
    v_max3_f32 v165, v165, v79, v80
    v_max3_f32 v165, v165, v81, v82
    v_max3_f32 v165, v165, v83, v84
    v_max3_f32 v165, v165, v85, v86
    v_max3_f32 v165, v165, v87, v88
    v_max3_f32 v165, v165, v89, v90
    v_max_f32 v165, v165, v91
    v_mov_b32 v166, v165
    s_nop 1
    v_permlane32_swap_b32 v165, v166
    v_max3_f32 v165, v165, v166, v164
    v_sub_f32 v166, v164, v165
    v_exp_f32 v166, v166
    v_mov_b32 v164, v165
    v_mul_f32 v44, v44, v166
    v_mul_f32 v45, v45, v166
    v_mul_f32 v46, v46, v166
    v_mul_f32 v47, v47, v166
    v_mul_f32 v48, v48, v166
    v_mul_f32 v49, v49, v166
    v_mul_f32 v50, v50, v166
    v_mul_f32 v51, v51, v166
    v_mul_f32 v52, v52, v166
    v_mul_f32 v53, v53, v166
    v_mul_f32 v54, v54, v166
    v_mul_f32 v55, v55, v166
    v_mul_f32 v56, v56, v166
    v_mul_f32 v57, v57, v166
    v_mul_f32 v58, v58, v166
    v_mul_f32 v59, v59, v166
    v_sub_f32 v76, v76, v165
    v_sub_f32 v77, v77, v165
    v_sub_f32 v78, v78, v165
    v_sub_f32 v79, v79, v165
    v_sub_f32 v80, v80, v165
    v_sub_f32 v81, v81, v165
    v_sub_f32 v82, v82, v165
    v_sub_f32 v83, v83, v165
    v_sub_f32 v84, v84, v165
    v_sub_f32 v85, v85, v165
    v_sub_f32 v86, v86, v165
    v_sub_f32 v87, v87, v165
    v_sub_f32 v88, v88, v165
    v_sub_f32 v89, v89, v165
    v_sub_f32 v90, v90, v165
    v_sub_f32 v91, v91, v165
    v_exp_f32 v76, v76
    v_exp_f32 v77, v77
    v_exp_f32 v78, v78
    v_exp_f32 v79, v79
    v_exp_f32 v80, v80
    v_exp_f32 v81, v81
    v_exp_f32 v82, v82
    v_exp_f32 v83, v83
    v_exp_f32 v84, v84
    v_exp_f32 v85, v85
    v_exp_f32 v86, v86
    v_exp_f32 v87, v87
    v_exp_f32 v88, v88
    v_exp_f32 v89, v89
    v_exp_f32 v90, v90
    v_exp_f32 v91, v91
    s_nop 0
    v_cvt_pk_bf16_f32 v108, v76, v77
    v_cvt_pk_bf16_f32 v109, v78, v79
    v_cvt_pk_bf16_f32 v110, v80, v81
    v_cvt_pk_bf16_f32 v111, v82, v83
    v_cvt_pk_bf16_f32 v112, v84, v85
    v_cvt_pk_bf16_f32 v113, v86, v87
    v_cvt_pk_bf16_f32 v114, v88, v89
    v_cvt_pk_bf16_f32 v115, v90, v91
    s_nop 1
    v_mfma_f32_32x32x16_bf16 v[44:59], v[132:135], v[108:111], v[44:59]
    v_mfma_f32_32x32x16_bf16 v[44:59], v[136:139], v[112:115], v[44:59]
    s_add_u32 s32, s32, 1024
    s_add_u32 s33, s33, 1024
    s_sub_u32 s36, s36, 1
    s_nop 15
    s_cmp_lg_u32 s36, 0
    s_cbranch_scc1 K3_SLOOP
    s_branch K3_FIN
K3_PF:
    s_setprio 3
    v_mov_b32 v1, v160
    v_mov_b32 v12, 0
    ds_read_b32 v13, v12
    s_load_dwordx2 s[16:17], s[0:1], 16
    s_mov_b32 s18, 524288
    s_mov_b32 s19, 0x20000
    s_and_b32 s20, s2, 1
    s_lshl_b32 s20, s20, 2
    s_bfe_u32 s21, s2, 0x20001
    s_add_u32 s20, s20, s21
    s_lshl_b32 s20, s20, 2
    s_bfe_u32 s21, s2, 0x20003
    s_add_u32 s20, s20, s21
    s_lshl_b32 s25, s20, 16
    s_add_u32 s25, s25, 7346176
    s_add_u32 s26, s25, 2097152
    s_add_u32 s27, s25, 32768
    s_add_u32 s28, s26, 32768
    s_mov_b32 s29, 6144
    s_mov_b32 s30, 71872
    v_lshlrev_b32 v2, 4, v1
    v_mul_u32_u24 v3, 1056, v1
    v_add_u32 v3, 66560, v3
    v_mov_b32 v4, 0x3f803f80
    v_mov_b32 v5, 0x3f803f80
    v_mov_b32 v6, 0x3f803f80
    v_mov_b32 v7, 0x3f803f80
    v_mov_b32 v8, 0
    v_mov_b32 v9, 0
    v_mov_b32 v10, 0
    v_mov_b32 v11, 0
    ds_write_b128 v3, v[4:7]
    ds_write_b128 v3, v[8:11] offset:16
    s_waitcnt lgkmcnt(0)
    v_readfirstlane_b32 s60, v13
    s_lshr_b32 s61, s20, 2
    s_and_b32 s62, s61, 3
    s_lshl_b32 s62, s62, 6
    s_lshr_b32 s61, s61, 2
    s_add_u32 s61, s61, s62
    s_lshl_b32 s61, s61, 7
    s_add_u32 s61, s61, 786432
    v_and_b32 v12, 7, v1
    v_lshlrev_b32 v12, 10, v12
    v_bfe_u32 v13, v1, 3, 2
    v_lshl_add_u32 v12, v13, 8, v12
    s_mov_b32 s62, 0
    s_lshr_b32 s63, s2, 5
    s_lshl_b32 s63, s63, 2
    s_lshl_b32 s63, 15, s63
    s_or_b32 exec_lo, s63, 0x00070007
    s_mov_b32 exec_hi, 0
K3_QPa:
    buffer_load_dword v13, v12, s[8:11], s61 offen sc1
    s_add_u32 s62, s62, 1
    s_waitcnt vmcnt(0)
    v_cmp_ne_u32 vcc, s60, v13
    s_cmp_gt_u32 s62, 0x100000
    s_cbranch_scc1 K3_QXa
    s_and_b64 exec, exec, vcc
    s_cbranch_execnz K3_QPa
K3_QXa:
    s_mov_b64 exec, -1
    s_barrier
    s_mov_b32 exec_hi, 0
K3_QPb:
    buffer_load_dword v13, v12, s[8:11], s61 offen sc1
    s_add_u32 s62, s62, 1
    s_waitcnt vmcnt(0)
    v_cmp_ne_u32 vcc, s60, v13
    s_cmp_gt_u32 s62, 0x100000
    s_cbranch_scc1 K3_QXb
    s_and_b64 exec, exec, vcc
    s_cbranch_execnz K3_QPb
K3_QXb:
    s_mov_b64 exec, -1
    s_mov_b32 s31, 12
K3_KV0:
    s_mov_b32 m0, s29
    s_add_u32 s29, s29, 1024
    buffer_load_dwordx4 v2, s[8:11], s25 offen lds
    s_add_u32 m0, m0, 32768
    s_add_u32 s25, s25, 1024
    buffer_load_dwordx4 v2, s[8:11], s27 offen lds
    s_mov_b32 m0, s30
    s_add_u32 s27, s27, 1024
    buffer_load_dwordx4 v2, s[8:11], s26 offen lds
    s_add_u32 m0, m0, 33792
    s_add_u32 s26, s26, 1024
    buffer_load_dwordx4 v2, s[8:11], s28 offen lds
    s_add_u32 s30, s30, 1056
    s_add_u32 s28, s28, 1024
    s_sub_u32 s31, s31, 1
    s_waitcnt vmcnt(40)
    s_cmp_lg_u32 s31, 0
    s_cbranch_scc1 K3_KV0
    s_waitcnt vmcnt(32)
    s_barrier
    s_mov_b32 s31, 14
K3_KV1:
    s_mov_b32 m0, s29
    s_add_u32 s29, s29, 1024
    buffer_load_dwordx4 v2, s[8:11], s25 offen lds
    s_add_u32 m0, m0, 32768
    s_add_u32 s25, s25, 1024
    buffer_load_dwordx4 v2, s[8:11], s27 offen lds
    s_mov_b32 m0, s30
    s_add_u32 s27, s27, 1024
    buffer_load_dwordx4 v2, s[8:11], s26 offen lds
    s_add_u32 m0, m0, 33792
    s_add_u32 s26, s26, 1024
    buffer_load_dwordx4 v2, s[8:11], s28 offen lds
    s_add_u32 s30, s30, 1056
    s_add_u32 s28, s28, 1024
    s_sub_u32 s31, s31, 1
    s_waitcnt vmcnt(40)
    s_cmp_lg_u32 s31, 0
    s_cbranch_scc1 K3_KV1
    s_waitcnt vmcnt(0)
    s_barrier
    v_lshlrev_b32 v12, 7, v1
    s_mov_b32 s61, 786432
    s_mov_b32 s63, 4
K3_AP:
    buffer_load_dword v13, v12, s[8:11], s61 offen sc1
    s_add_u32 s62, s62, 1
    s_waitcnt vmcnt(0)
    v_cmp_ne_u32 vcc, s60, v13
    s_cmp_gt_u32 s62, 0x200000
    s_cbranch_scc1 K3_AN
    s_cbranch_vccnz K3_AP
K3_AN:
    s_add_u32 s61, s61, 8192
    s_sub_u32 s63, s63, 1
    s_cmp_lg_u32 s63, 0
    s_cbranch_scc1 K3_AP
    s_load_dwordx2 s[20:21], s[0:1], 40
    s_mov_b32 s22, 1835008
    s_mov_b32 s23, 0x20000
    s_load_dwordx2 s[24:25], s[0:1], 48
    s_mov_b32 s26, 1835008
    s_mov_b32 s27, 0x20000
    s_load_dwordx2 s[28:29], s[0:1], 56
    s_mov_b32 s30, 1835008
    s_mov_b32 s31, 0x20000
    s_load_dwordx2 s[36:37], s[0:1], 32
    s_mov_b32 s38, 1024
    s_mov_b32 s39, 0x20000
    s_getpc_b64 s[32:33]
K3_PCa:
    s_add_u32 s32, s32, k5_kernel-K3_PCa
    s_addc_u32 s33, s33, 0
    s_mov_b32 s34, K_CODE_END-k5_kernel
    s_mov_b32 s35, 0x20000
    s_and_b32 s41, s2, 7
    s_lshr_b32 s42, s2, 3
    v_lshlrev_b32 v2, 7, v1
    v_lshrrev_b32 v3, 2, v1
    v_mul_u32_u24 v3, 3584, v3
    v_and_b32 v4, 3, v1
    v_lshl_add_u32 v3, v4, 7, v3
    s_lshl_b32 s43, s42, 14
    s_add_u32 s44, s43, 8192
    s_lshl_b32 s45, s41, 18
    s_lshl_b32 s46, s42, 13
    s_add_u32 s45, s45, s46
    s_and_b32 s46, s42, 1
    s_lshl_b32 s46, s46, 13
    s_mul_i32 s47, s41, 7
    s_lshr_b32 s47, s47, 1
    s_lshl_b32 s47, s47, 7
    s_mul_i32 s48, s42, 57344
    s_add_u32 s47, s47, s48
    s_min_u32 s48, s42, 27
    s_lshl_b32 s48, s48, 13
    s_mul_i32 s49, s41, 229376
    s_add_u32 s48, s48, s49
    s_lshr_b32 s54, s2, 5
    s_lshl_b32 s45, s41, 2
    s_and_b32 s55, s42, 3
    s_add_u32 s45, s45, s55
    s_lshl_b32 s45, s45, 16
    s_lshl_b32 s55, s54, 7
    s_add_u32 s45, s45, s55
    v_lshlrev_b32 v100, 10, v1
    v_lshrrev_b32 v101, 3, v1
    v_bfe_u32 v102, v1, 4, 1
    v_lshlrev_b32 v102, 2, v102
    v_and_b32 v103, 7, v1
    v_xor_b32 v102, v102, v103
    v_lshlrev_b32 v101, 10, v101
    v_lshl_add_u32 v101, v102, 4, v101
    v_lshlrev_b32 v104, 2, v1
    v_lshlrev_b32 v105, 1, v1
    v_add_u32 v106, 131072, v104
    s_lshl_b32 s56, s54, 8
    s_waitcnt lgkmcnt(0)
    s_add_u32 s57, s56, 655360
    buffer_load_dword v108, v104, s[8:11], s57 offen sc1
    s_add_u32 s57, s57, 4096
    buffer_load_dword v124, v104, s[8:11], s57 offen sc1
    s_add_u32 s57, s56, 663552
    buffer_load_dword v109, v104, s[8:11], s57 offen sc1
    s_add_u32 s57, s57, 4096
    buffer_load_dword v125, v104, s[8:11], s57 offen sc1
    s_add_u32 s57, s56, 671744
    buffer_load_dword v110, v104, s[8:11], s57 offen sc1
    s_add_u32 s57, s57, 4096
    buffer_load_dword v126, v104, s[8:11], s57 offen sc1
    s_add_u32 s57, s56, 679936
    buffer_load_dword v111, v104, s[8:11], s57 offen sc1
    s_add_u32 s57, s57, 4096
    buffer_load_dword v127, v104, s[8:11], s57 offen sc1
    s_add_u32 s57, s56, 688128
    buffer_load_dword v112, v104, s[8:11], s57 offen sc1
    s_add_u32 s57, s57, 4096
    buffer_load_dword v128, v104, s[8:11], s57 offen sc1
    s_add_u32 s57, s56, 696320
    buffer_load_dword v113, v104, s[8:11], s57 offen sc1
    s_add_u32 s57, s57, 4096
    buffer_load_dword v129, v104, s[8:11], s57 offen sc1
    s_add_u32 s57, s56, 704512
    buffer_load_dword v114, v104, s[8:11], s57 offen sc1
    s_add_u32 s57, s57, 4096
    buffer_load_dword v130, v104, s[8:11], s57 offen sc1
    s_add_u32 s57, s56, 712704
    buffer_load_dword v115, v104, s[8:11], s57 offen sc1
    s_add_u32 s57, s57, 4096
    buffer_load_dword v131, v104, s[8:11], s57 offen sc1
    s_add_u32 s57, s56, 720896
    buffer_load_dword v116, v104, s[8:11], s57 offen sc1
    s_add_u32 s57, s57, 4096
    buffer_load_dword v132, v104, s[8:11], s57 offen sc1
    s_add_u32 s57, s56, 729088
    buffer_load_dword v117, v104, s[8:11], s57 offen sc1
    s_add_u32 s57, s57, 4096
    buffer_load_dword v133, v104, s[8:11], s57 offen sc1
    s_add_u32 s57, s56, 737280
    buffer_load_dword v118, v104, s[8:11], s57 offen sc1
    s_add_u32 s57, s57, 4096
    buffer_load_dword v134, v104, s[8:11], s57 offen sc1
    s_add_u32 s57, s56, 745472
    buffer_load_dword v119, v104, s[8:11], s57 offen sc1
    s_add_u32 s57, s57, 4096
    buffer_load_dword v135, v104, s[8:11], s57 offen sc1
    s_add_u32 s57, s56, 753664
    buffer_load_dword v120, v104, s[8:11], s57 offen sc1
    s_add_u32 s57, s57, 4096
    buffer_load_dword v136, v104, s[8:11], s57 offen sc1
    s_add_u32 s57, s56, 761856
    buffer_load_dword v121, v104, s[8:11], s57 offen sc1
    s_add_u32 s57, s57, 4096
    buffer_load_dword v137, v104, s[8:11], s57 offen sc1
    s_add_u32 s57, s56, 770048
    buffer_load_dword v122, v104, s[8:11], s57 offen sc1
    s_add_u32 s57, s57, 4096
    buffer_load_dword v138, v104, s[8:11], s57 offen sc1
    s_add_u32 s57, s56, 778240
    buffer_load_dword v123, v104, s[8:11], s57 offen sc1
    s_add_u32 s57, s57, 4096
    buffer_load_dword v139, v104, s[8:11], s57 offen sc1
    buffer_load_ushort v140, v105, s[36:39], s55 offen
    s_waitcnt vmcnt(0)
    v_add_f32 v108, v108, v116
    v_add_f32 v124, v124, v132
    v_add_f32 v109, v109, v117
    v_add_f32 v125, v125, v133
    v_add_f32 v110, v110, v118
    v_add_f32 v126, v126, v134
    v_add_f32 v111, v111, v119
    v_add_f32 v127, v127, v135
    v_add_f32 v112, v112, v120
    v_add_f32 v128, v128, v136
    v_add_f32 v113, v113, v121
    v_add_f32 v129, v129, v137
    v_add_f32 v114, v114, v122
    v_add_f32 v130, v130, v138
    v_add_f32 v115, v115, v123
    v_add_f32 v131, v131, v139
    v_add_f32 v108, v108, v112
    v_add_f32 v124, v124, v128
    v_add_f32 v109, v109, v113
    v_add_f32 v125, v125, v129
    v_add_f32 v110, v110, v114
    v_add_f32 v126, v126, v130
    v_add_f32 v111, v111, v115
    v_add_f32 v127, v127, v131
    v_add_f32 v108, v108, v110
    v_add_f32 v124, v124, v126
    v_add_f32 v109, v109, v111
    v_add_f32 v125, v125, v127
    v_add_f32 v108, v108, v109
    v_add_f32 v124, v124, v125
    v_cvt_pk_bf16_f32 v108, v108, v108
    v_cvt_pk_bf16_f32 v124, v124, v124
    v_and_b32 v108, 0xffff0000, v108
    v_and_b32 v124, 0xffff0000, v124
    v_add_f32 v124, 1.0, v124
    v_lshlrev_b32 v140, 16, v140
    v_cvt_pk_bf16_f32 v124, v124, v124
    v_and_b32 v124, 0xffff0000, v124
    v_mul_f32 v124, v124, v140
    v_add_u32 v104, 133120, v104
    ds_write_b32 v104, v108
    ds_write_b32 v104, v124 offset:256
    s_cmp_ge_u32 s2, 8
    s_cbranch_scc1 K3_PF2
    v_lshlrev_b32 v6, 4, v1
    s_lshl_b32 s50, s2, 10
    s_add_u32 s50, s50, 4096
    s_add_u32 s51, s50, 651264
    buffer_load_dwordx4 v[32:35], v6, s[8:11], s51 offen sc1
    s_add_u32 s51, s50, 659456
    buffer_load_dwordx4 v[36:39], v6, s[8:11], s51 offen sc1
    s_add_u32 s51, s50, 667648
    buffer_load_dwordx4 v[40:43], v6, s[8:11], s51 offen sc1
    s_add_u32 s51, s50, 675840
    buffer_load_dwordx4 v[44:47], v6, s[8:11], s51 offen sc1
    s_add_u32 s51, s50, 684032
    buffer_load_dwordx4 v[48:51], v6, s[8:11], s51 offen sc1
    s_add_u32 s51, s50, 692224
    buffer_load_dwordx4 v[52:55], v6, s[8:11], s51 offen sc1
    s_add_u32 s51, s50, 700416
    buffer_load_dwordx4 v[56:59], v6, s[8:11], s51 offen sc1
    s_add_u32 s51, s50, 708608
    buffer_load_dwordx4 v[60:63], v6, s[8:11], s51 offen sc1
    s_add_u32 s51, s50, 716800
    buffer_load_dwordx4 v[64:67], v6, s[8:11], s51 offen sc1
    s_add_u32 s51, s50, 724992
    buffer_load_dwordx4 v[68:71], v6, s[8:11], s51 offen sc1
    s_add_u32 s51, s50, 733184
    buffer_load_dwordx4 v[72:75], v6, s[8:11], s51 offen sc1
    s_add_u32 s51, s50, 741376
    buffer_load_dwordx4 v[76:79], v6, s[8:11], s51 offen sc1
    s_add_u32 s51, s50, 749568
    buffer_load_dwordx4 v[80:83], v6, s[8:11], s51 offen sc1
    s_add_u32 s51, s50, 757760
    buffer_load_dwordx4 v[84:87], v6, s[8:11], s51 offen sc1
    s_add_u32 s51, s50, 765952
    buffer_load_dwordx4 v[88:91], v6, s[8:11], s51 offen sc1
    s_add_u32 s51, s50, 774144
    buffer_load_dwordx4 v[92:95], v6, s[8:11], s51 offen sc1
    v_lshlrev_b32 v7, 3, v1
    s_and_b32 s51, s2, 1
    s_lshl_b32 s51, s51, 9
    s_lshr_b32 s52, s2, 1
    s_cmp_eq_u32 s52, 2
    s_cselect_b32 s53, 1.0, 0
    s_waitcnt lgkmcnt(0)
    buffer_load_dwordx2 v[24:25], v7, s[36:39], s51 offen
    s_waitcnt vmcnt(0)
    v_add_f32 v32, v32, v64
    v_add_f32 v33, v33, v65
    v_add_f32 v34, v34, v66
    v_add_f32 v35, v35, v67
    v_add_f32 v36, v36, v68
    v_add_f32 v37, v37, v69
    v_add_f32 v38, v38, v70
    v_add_f32 v39, v39, v71
    v_add_f32 v40, v40, v72
    v_add_f32 v41, v41, v73
    v_add_f32 v42, v42, v74
    v_add_f32 v43, v43, v75
    v_add_f32 v44, v44, v76
    v_add_f32 v45, v45, v77
    v_add_f32 v46, v46, v78
    v_add_f32 v47, v47, v79
    v_add_f32 v48, v48, v80
    v_add_f32 v49, v49, v81
    v_add_f32 v50, v50, v82
    v_add_f32 v51, v51, v83
    v_add_f32 v52, v52, v84
    v_add_f32 v53, v53, v85
    v_add_f32 v54, v54, v86
    v_add_f32 v55, v55, v87
    v_add_f32 v56, v56, v88
    v_add_f32 v57, v57, v89
    v_add_f32 v58, v58, v90
    v_add_f32 v59, v59, v91
    v_add_f32 v60, v60, v92
    v_add_f32 v61, v61, v93
    v_add_f32 v62, v62, v94
    v_add_f32 v63, v63, v95
    v_add_f32 v32, v32, v48
    v_add_f32 v33, v33, v49
    v_add_f32 v34, v34, v50
    v_add_f32 v35, v35, v51
    v_add_f32 v36, v36, v52
    v_add_f32 v37, v37, v53
    v_add_f32 v38, v38, v54
    v_add_f32 v39, v39, v55
    v_add_f32 v40, v40, v56
    v_add_f32 v41, v41, v57
    v_add_f32 v42, v42, v58
    v_add_f32 v43, v43, v59
    v_add_f32 v44, v44, v60
    v_add_f32 v45, v45, v61
    v_add_f32 v46, v46, v62
    v_add_f32 v47, v47, v63
    v_add_f32 v32, v32, v40
    v_add_f32 v33, v33, v41
    v_add_f32 v34, v34, v42
    v_add_f32 v35, v35, v43
    v_add_f32 v36, v36, v44
    v_add_f32 v37, v37, v45
    v_add_f32 v38, v38, v46
    v_add_f32 v39, v39, v47
    v_add_f32 v8, v32, v36
    v_add_f32 v9, v33, v37
    v_add_f32 v10, v34, v38
    v_add_f32 v11, v35, v39
    v_cvt_pk_bf16_f32 v8, v8, v8
    v_cvt_pk_bf16_f32 v9, v9, v9
    v_cvt_pk_bf16_f32 v10, v10, v10
    v_cvt_pk_bf16_f32 v11, v11, v11
    v_and_b32 v8, 0xffff0000, v8
    v_and_b32 v9, 0xffff0000, v9
    v_and_b32 v10, 0xffff0000, v10
    v_and_b32 v11, 0xffff0000, v11
    v_add_f32 v8, s53, v8
    v_add_f32 v9, s53, v9
    v_add_f32 v10, s53, v10
    v_add_f32 v11, s53, v11
    v_cvt_pk_bf16_f32 v8, v8, v8
    v_cvt_pk_bf16_f32 v9, v9, v9
    v_cvt_pk_bf16_f32 v10, v10, v10
    v_cvt_pk_bf16_f32 v11, v11, v11
    v_and_b32 v8, 0xffff0000, v8
    v_and_b32 v9, 0xffff0000, v9
    v_and_b32 v10, 0xffff0000, v10
    v_and_b32 v11, 0xffff0000, v11
    s_add_u32 s53, s50, 0
    buffer_store_dwordx4 v[8:11], v6, s[8:11], s53 offen sc1
    v_lshlrev_b32 v26, 16, v24
    v_and_b32 v27, 0xffff0000, v24
    v_lshlrev_b32 v28, 16, v25
    v_and_b32 v29, 0xffff0000, v25
    v_mul_f32 v12, v8, v26
    v_mul_f32 v13, v9, v27
    v_mul_f32 v14, v10, v28
    v_mul_f32 v15, v11, v29
    v_add_f32 v16, v12, v13
    v_add_f32 v17, v14, v15
    v_add_f32 v16, v16, v17
    s_nop 1
    v_add_f32_dpp v16, v16, v16 quad_perm:[1,0,3,2] row_mask:0xf bank_mask:0xf
    s_nop 1
    v_add_f32_dpp v16, v16, v16 quad_perm:[2,3,0,1] row_mask:0xf bank_mask:0xf
    s_nop 1
    v_add_f32_dpp v16, v16, v16 row_ror:4 row_mask:0xf bank_mask:0xf
    s_nop 1
    v_add_f32_dpp v16, v16, v16 row_ror:8 row_mask:0xf bank_mask:0xf
    v_mov_b32 v17, v16
    s_nop 1
    v_permlane16_swap_b32 v16, v17
    s_nop 1
    v_add_f32 v16, v16, v17
    v_mov_b32 v17, v16
    s_nop 1
    v_permlane32_swap_b32 v16, v17
    s_nop 1
    v_add_f32 v16, v16, v17
    s_cmp_eq_u32 s52, 2
    s_cbranch_scc0 K3_NCV
    s_lshl_b32 s53, s51, 1
    s_add_u32 s53, s53, 12288
    buffer_store_dwordx4 v[12:15], v6, s[8:11], s53 offen
K3_NCV:
    s_lshl_b32 s53, s2, 2
    s_add_u32 s53, s53, 14336
    v_mov_b32 v17, 0
    s_mov_b64 exec, 1
    v_min_u32 v16, 0xfffffffe, v16
    buffer_store_dword v16, v17, s[8:11], s53 offen sc1
    s_mov_b64 exec, -1
K3_PF2:
    buffer_load_dword v5, v2, s[16:19], s43 offen
    s_waitcnt vmcnt(2)
    buffer_load_dword v5, v2, s[16:19], s44 offen
    s_waitcnt vmcnt(2)
    buffer_load_dword v5, v100, s[12:15], s45 offen
    s_waitcnt vmcnt(2)
    buffer_load_dword v5, v2, s[32:35], s46 offen
    s_waitcnt vmcnt(2)
    buffer_load_dword v5, v3, s[20:23], s47 offen
    s_waitcnt vmcnt(2)
    buffer_load_dword v5, v3, s[24:27], s47 offen
    s_waitcnt vmcnt(2)
    buffer_load_dword v5, v2, s[28:31], s48 offen
    s_waitcnt vmcnt(2)
    s_waitcnt vmcnt(0) lgkmcnt(0)
    s_endpgm
.text
.globl k5_kernel
.p2align 8
.type k5_kernel,@function
k5_kernel:
    s_cmp_ge_u32 s2, 256
    s_cbranch_scc1 K5_END
    s_load_dwordx2 s[8:9], s[0:1], 96
    s_mov_b32 s10, 23068672
    s_mov_b32 s11, 0x20000
    v_readfirstlane_b32 s24, v0
    s_lshr_b32 s24, s24, 6
    v_and_b32 v1, 63, v0
    v_lshlrev_b32 v2, 5, v0
    s_mov_b32 s25, 16384
    s_mov_b32 s26, 24576
    s_mov_b32 s27, 32768
    v_mov_b32 v6, 0
    s_mov_b32 s33, 14344
    s_cmp_ge_u32 s24, 4
    s_waitcnt lgkmcnt(0)
    s_cbranch_scc1 K5_NST
    buffer_load_dwordx4 v[112:115], v2, s[8:11], s25 offen offset:0
    buffer_load_dwordx4 v[116:119], v2, s[8:11], s25 offen offset:16
    buffer_load_dwordx4 v[120:123], v2, s[8:11], s26 offen offset:0
    buffer_load_dwordx4 v[124:127], v2, s[8:11], s26 offen offset:16
    buffer_load_dwordx4 v[128:131], v2, s[8:11], s27 offen offset:0
    buffer_load_dwordx4 v[132:135], v2, s[8:11], s27 offen offset:16
    buffer_load_dwordx4 v[140:143], v6, s[8:11], s33 offen
K5_NST:
    s_cmp_lt_u32 s2, 112
    s_cbranch_scc1 K5_MLP
    s_cmp_ge_u32 s2, 240
    s_cbranch_scc1 K5_FIN
    s_load_dwordx2 s[12:13], s[0:1], 80
    s_mov_b32 s14, 2097152
    s_mov_b32 s15, 0x20000
    s_sub_u32 s20, s2, 112
    s_and_b32 s21, s20, 7
    s_lshl_b32 s21, s21, 4
    s_lshr_b32 s20, s20, 3
    s_add_u32 s20, s20, s21
    s_lshl_b32 s20, s20, 3
    s_add_u32 s20, s20, s24
    s_lshl_b32 s21, s20, 11
    s_add_u32 s23, s21, 13631488
    s_lshl_b32 s22, s20, 3
    s_add_u32 s22, s22, 16384
    v_lshlrev_b32 v2, 4, v1
    v_lshlrev_b32 v3, 5, v1
    v_mov_b32 v4, 0
    s_mov_b32 s25, 6144
    s_mov_b32 s26, 10240
    s_add_u32 s27, s22, 8192
    s_waitcnt lgkmcnt(0)
    buffer_load_dwordx2 v[8:9], v4, s[8:11], s22 offen
    buffer_load_dwordx2 v[12:13], v4, s[8:11], s27 offen
    buffer_load_dwordx4 v[32:35], v3, s[8:11], s25 offen offset:0
    buffer_load_dwordx4 v[40:43], v3, s[8:11], s25 offen offset:2048
    buffer_load_dwordx4 v[48:51], v3, s[8:11], s26 offen offset:0
    buffer_load_dwordx4 v[36:39], v3, s[8:11], s25 offen offset:16
    buffer_load_dwordx4 v[44:47], v3, s[8:11], s25 offen offset:2064
    buffer_load_dwordx4 v[52:55], v3, s[8:11], s26 offen offset:16
    buffer_load_dwordx4 v[16:19], v2, s[8:11], s23 offen offset:0
    buffer_load_dwordx4 v[20:23], v2, s[8:11], s23 offen offset:1024
    s_waitcnt vmcnt(8)
    v_mul_f32 v8, 0x3b000000, v8
    v_mul_f32 v9, 0x3b000000, v9
    v_mul_f32 v12, 0x3b000000, v12
    v_mul_f32 v13, 0x3b000000, v13
    v_fma_f32 v12, -v8, v8, v12
    v_fma_f32 v13, -v9, v9, v13
    v_max_f32 v12, 0, v12
    v_max_f32 v13, 0, v13
    v_cvt_pk_bf16_f32 v8, v8, v8
    v_cvt_pk_bf16_f32 v9, v9, v9
    v_cvt_pk_bf16_f32 v12, v12, v12
    v_cvt_pk_bf16_f32 v13, v13, v13
    v_and_b32 v8, 0xffff0000, v8
    v_and_b32 v9, 0xffff0000, v9
    v_and_b32 v12, 0xffff0000, v12
    v_and_b32 v13, 0xffff0000, v13
    v_add_f32 v12, 0x3727c5ac, v12
    v_add_f32 v13, 0x3727c5ac, v13
    v_cvt_pk_bf16_f32 v12, v12, v12
    v_cvt_pk_bf16_f32 v13, v13, v13
    v_and_b32 v12, 0xffff0000, v12
    v_and_b32 v13, 0xffff0000, v13
    v_sqrt_f32 v12, v12
    v_sqrt_f32 v13, v13
    s_nop 0
    v_cvt_pk_bf16_f32 v12, v12, v12
    v_cvt_pk_bf16_f32 v13, v13, v13
    v_and_b32 v12, 0xffff0000, v12
    v_and_b32 v13, 0xffff0000, v13
    v_rcp_f32 v12, v12
    v_rcp_f32 v13, v13
    s_nop 0
    s_waitcnt vmcnt(1)
    v_lshlrev_b32 v56, 16, v16
    v_and_b32 v57, 0xffff0000, v16
    v_lshlrev_b32 v58, 16, v17
    v_and_b32 v59, 0xffff0000, v17
    v_lshlrev_b32 v60, 16, v18
    v_and_b32 v61, 0xffff0000, v18
    v_lshlrev_b32 v62, 16, v19
    v_and_b32 v63, 0xffff0000, v19
    v_sub_f32 v64, v56, v8
    v_sub_f32 v65, v57, v8
    v_sub_f32 v66, v58, v8
    v_sub_f32 v67, v59, v8
    v_sub_f32 v68, v60, v8
    v_sub_f32 v69, v61, v8
    v_sub_f32 v70, v62, v8
    v_sub_f32 v71, v63, v8
    v_cvt_pk_bf16_f32 v72, v64, v65
    v_cvt_pk_bf16_f32 v73, v66, v67
    v_cvt_pk_bf16_f32 v74, v68, v69
    v_cvt_pk_bf16_f32 v75, v70, v71
    v_lshlrev_b32 v64, 16, v72
    v_and_b32 v65, 0xffff0000, v72
    v_lshlrev_b32 v66, 16, v73
    v_and_b32 v67, 0xffff0000, v73
    v_lshlrev_b32 v68, 16, v74
    v_and_b32 v69, 0xffff0000, v74
    v_lshlrev_b32 v70, 16, v75
    v_and_b32 v71, 0xffff0000, v75
    v_mul_f32 v64, v64, v12
    v_mul_f32 v65, v65, v12
    v_mul_f32 v66, v66, v12
    v_mul_f32 v67, v67, v12
    v_mul_f32 v68, v68, v12
    v_mul_f32 v69, v69, v12
    v_mul_f32 v70, v70, v12
    v_mul_f32 v71, v71, v12
    v_cvt_pk_bf16_f32 v72, v64, v65
    v_cvt_pk_bf16_f32 v73, v66, v67
    v_cvt_pk_bf16_f32 v74, v68, v69
    v_cvt_pk_bf16_f32 v75, v70, v71
    v_lshlrev_b32 v64, 16, v72
    v_and_b32 v65, 0xffff0000, v72
    v_lshlrev_b32 v66, 16, v73
    v_and_b32 v67, 0xffff0000, v73
    v_lshlrev_b32 v68, 16, v74
    v_and_b32 v69, 0xffff0000, v74
    v_lshlrev_b32 v70, 16, v75
    v_and_b32 v71, 0xffff0000, v75
    v_pk_mul_f32 v[64:65], v[64:65], v[40:41]
    v_pk_mul_f32 v[66:67], v[66:67], v[42:43]
    v_pk_mul_f32 v[68:69], v[68:69], v[44:45]
    v_pk_mul_f32 v[70:71], v[70:71], v[46:47]
    v_cvt_pk_bf16_f32 v72, v64, v65
    v_cvt_pk_bf16_f32 v73, v66, v67
    v_cvt_pk_bf16_f32 v74, v68, v69
    v_cvt_pk_bf16_f32 v75, v70, v71
    v_lshlrev_b32 v64, 16, v72
    v_and_b32 v65, 0xffff0000, v72
    v_lshlrev_b32 v66, 16, v73
    v_and_b32 v67, 0xffff0000, v73
    v_lshlrev_b32 v68, 16, v74
    v_and_b32 v69, 0xffff0000, v74
    v_lshlrev_b32 v70, 16, v75
    v_and_b32 v71, 0xffff0000, v75
    v_pk_add_f32 v[64:65], v[64:65], v[32:33]
    v_pk_add_f32 v[66:67], v[66:67], v[34:35]
    v_pk_add_f32 v[68:69], v[68:69], v[36:37]
    v_pk_add_f32 v[70:71], v[70:71], v[38:39]
    v_cvt_pk_bf16_f32 v72, v64, v65
    v_cvt_pk_bf16_f32 v73, v66, v67
    v_cvt_pk_bf16_f32 v74, v68, v69
    v_cvt_pk_bf16_f32 v75, v70, v71
    v_lshlrev_b32 v64, 16, v72
    v_and_b32 v65, 0xffff0000, v72
    v_lshlrev_b32 v66, 16, v73
    v_and_b32 v67, 0xffff0000, v73
    v_lshlrev_b32 v68, 16, v74
    v_and_b32 v69, 0xffff0000, v74
    v_lshlrev_b32 v70, 16, v75
    v_and_b32 v71, 0xffff0000, v75
    v_pk_mul_f32 v[64:65], v[64:65], v[48:49]
    v_pk_mul_f32 v[66:67], v[66:67], v[50:51]
    v_pk_mul_f32 v[68:69], v[68:69], v[52:53]
    v_pk_mul_f32 v[70:71], v[70:71], v[54:55]
    v_cvt_pk_bf16_f32 v72, v64, v65
    v_cvt_pk_bf16_f32 v73, v66, v67
    v_cvt_pk_bf16_f32 v74, v68, v69
    v_cvt_pk_bf16_f32 v75, v70, v71
    v_lshlrev_b32 v64, 16, v72
    v_and_b32 v65, 0xffff0000, v72
    v_lshlrev_b32 v66, 16, v73
    v_and_b32 v67, 0xffff0000, v73
    v_lshlrev_b32 v68, 16, v74
    v_and_b32 v69, 0xffff0000, v74
    v_lshlrev_b32 v70, 16, v75
    v_and_b32 v71, 0xffff0000, v75
    v_pk_add_f32 v[64:65], v[64:65], v[56:57]
    v_pk_add_f32 v[66:67], v[66:67], v[58:59]
    v_pk_add_f32 v[68:69], v[68:69], v[60:61]
    v_pk_add_f32 v[70:71], v[70:71], v[62:63]
    v_cvt_pk_bf16_f32 v16, v64, v65
    v_cvt_pk_bf16_f32 v17, v66, v67
    v_cvt_pk_bf16_f32 v18, v68, v69
    v_cvt_pk_bf16_f32 v19, v70, v71
    buffer_store_dwordx4 v[16:19], v2, s[12:15], s21 offen offset:0 sc1
    s_waitcnt vmcnt(1)
    v_lshlrev_b32 v56, 16, v20
    v_and_b32 v57, 0xffff0000, v20
    v_lshlrev_b32 v58, 16, v21
    v_and_b32 v59, 0xffff0000, v21
    v_lshlrev_b32 v60, 16, v22
    v_and_b32 v61, 0xffff0000, v22
    v_lshlrev_b32 v62, 16, v23
    v_and_b32 v63, 0xffff0000, v23
    v_sub_f32 v64, v56, v9
    v_sub_f32 v65, v57, v9
    v_sub_f32 v66, v58, v9
    v_sub_f32 v67, v59, v9
    v_sub_f32 v68, v60, v9
    v_sub_f32 v69, v61, v9
    v_sub_f32 v70, v62, v9
    v_sub_f32 v71, v63, v9
    v_cvt_pk_bf16_f32 v72, v64, v65
    v_cvt_pk_bf16_f32 v73, v66, v67
    v_cvt_pk_bf16_f32 v74, v68, v69
    v_cvt_pk_bf16_f32 v75, v70, v71
    v_lshlrev_b32 v64, 16, v72
    v_and_b32 v65, 0xffff0000, v72
    v_lshlrev_b32 v66, 16, v73
    v_and_b32 v67, 0xffff0000, v73
    v_lshlrev_b32 v68, 16, v74
    v_and_b32 v69, 0xffff0000, v74
    v_lshlrev_b32 v70, 16, v75
    v_and_b32 v71, 0xffff0000, v75
    v_mul_f32 v64, v64, v13
    v_mul_f32 v65, v65, v13
    v_mul_f32 v66, v66, v13
    v_mul_f32 v67, v67, v13
    v_mul_f32 v68, v68, v13
    v_mul_f32 v69, v69, v13
    v_mul_f32 v70, v70, v13
    v_mul_f32 v71, v71, v13
    v_cvt_pk_bf16_f32 v72, v64, v65
    v_cvt_pk_bf16_f32 v73, v66, v67
    v_cvt_pk_bf16_f32 v74, v68, v69
    v_cvt_pk_bf16_f32 v75, v70, v71
    v_lshlrev_b32 v64, 16, v72
    v_and_b32 v65, 0xffff0000, v72
    v_lshlrev_b32 v66, 16, v73
    v_and_b32 v67, 0xffff0000, v73
    v_lshlrev_b32 v68, 16, v74
    v_and_b32 v69, 0xffff0000, v74
    v_lshlrev_b32 v70, 16, v75
    v_and_b32 v71, 0xffff0000, v75
    v_pk_mul_f32 v[64:65], v[64:65], v[40:41]
    v_pk_mul_f32 v[66:67], v[66:67], v[42:43]
    v_pk_mul_f32 v[68:69], v[68:69], v[44:45]
    v_pk_mul_f32 v[70:71], v[70:71], v[46:47]
    v_cvt_pk_bf16_f32 v72, v64, v65
    v_cvt_pk_bf16_f32 v73, v66, v67
    v_cvt_pk_bf16_f32 v74, v68, v69
    v_cvt_pk_bf16_f32 v75, v70, v71
    v_lshlrev_b32 v64, 16, v72
    v_and_b32 v65, 0xffff0000, v72
    v_lshlrev_b32 v66, 16, v73
    v_and_b32 v67, 0xffff0000, v73
    v_lshlrev_b32 v68, 16, v74
    v_and_b32 v69, 0xffff0000, v74
    v_lshlrev_b32 v70, 16, v75
    v_and_b32 v71, 0xffff0000, v75
    v_pk_add_f32 v[64:65], v[64:65], v[32:33]
    v_pk_add_f32 v[66:67], v[66:67], v[34:35]
    v_pk_add_f32 v[68:69], v[68:69], v[36:37]
    v_pk_add_f32 v[70:71], v[70:71], v[38:39]
    v_cvt_pk_bf16_f32 v72, v64, v65
    v_cvt_pk_bf16_f32 v73, v66, v67
    v_cvt_pk_bf16_f32 v74, v68, v69
    v_cvt_pk_bf16_f32 v75, v70, v71
    v_lshlrev_b32 v64, 16, v72
    v_and_b32 v65, 0xffff0000, v72
    v_lshlrev_b32 v66, 16, v73
    v_and_b32 v67, 0xffff0000, v73
    v_lshlrev_b32 v68, 16, v74
    v_and_b32 v69, 0xffff0000, v74
    v_lshlrev_b32 v70, 16, v75
    v_and_b32 v71, 0xffff0000, v75
    v_pk_mul_f32 v[64:65], v[64:65], v[48:49]
    v_pk_mul_f32 v[66:67], v[66:67], v[50:51]
    v_pk_mul_f32 v[68:69], v[68:69], v[52:53]
    v_pk_mul_f32 v[70:71], v[70:71], v[54:55]
    v_cvt_pk_bf16_f32 v72, v64, v65
    v_cvt_pk_bf16_f32 v73, v66, v67
    v_cvt_pk_bf16_f32 v74, v68, v69
    v_cvt_pk_bf16_f32 v75, v70, v71
    v_lshlrev_b32 v64, 16, v72
    v_and_b32 v65, 0xffff0000, v72
    v_lshlrev_b32 v66, 16, v73
    v_and_b32 v67, 0xffff0000, v73
    v_lshlrev_b32 v68, 16, v74
    v_and_b32 v69, 0xffff0000, v74
    v_lshlrev_b32 v70, 16, v75
    v_and_b32 v71, 0xffff0000, v75
    v_pk_add_f32 v[64:65], v[64:65], v[56:57]
    v_pk_add_f32 v[66:67], v[66:67], v[58:59]
    v_pk_add_f32 v[68:69], v[68:69], v[60:61]
    v_pk_add_f32 v[70:71], v[70:71], v[62:63]
    v_cvt_pk_bf16_f32 v20, v64, v65
    v_cvt_pk_bf16_f32 v21, v66, v67
    v_cvt_pk_bf16_f32 v22, v68, v69
    v_cvt_pk_bf16_f32 v23, v70, v71
    buffer_store_dwordx4 v[20:23], v2, s[12:15], s21 offen offset:1024 sc1
    s_lshr_b32 s22, s20, 3
    s_lshl_b32 s22, s22, 7
    s_add_u32 s22, s22, 49152
    s_waitcnt vmcnt(0)
    s_barrier
    s_cmp_lg_u32 s24, 0
    s_cbranch_scc1 K5_EWX
    s_mov_b64 exec, 1
    buffer_store_dword v4, v4, s[8:11], s22 offen sc1
K5_EWX:
    s_endpgm
K5_FIN:
    s_cmp_lt_u32 s24, 4
    s_cbranch_scc1 K5_SEL
    s_load_dwordx2 s[12:13], s[0:1], 80
    s_mov_b32 s14, 2097152
    s_mov_b32 s15, 0x20000
    s_sub_u32 s20, s2, 240
    v_and_b32 v0, 255, v0
    v_lshrrev_b32 v1, 4, v0
    v_and_b32 v2, 15, v0
    v_lshlrev_b32 v3, 12, v1
    v_lshrrev_b32 v4, 3, v2
    v_and_b32 v5, 7, v2
    v_lshl_add_u32 v3, v4, 11, v3
    v_lshl_add_u32 v3, v5, 4, v3
    s_lshl_b32 s21, s20, 7
    s_add_u32 s25, s21, 10240
    s_add_u32 s21, s21, 65536
    s_add_u32 s26, s21, 65536
    s_add_u32 s27, s21, 131072
    s_add_u32 s28, s21, 196608
    s_add_u32 s29, s21, 262144
    s_add_u32 s30, s21, 327680
    s_add_u32 s31, s21, 393216
    v_lshlrev_b32 v8, 4, v5
    v_lshlrev_b32 v9, 4, v2
    v_lshrrev_b32 v10, 6, v0
    v_lshl_add_u32 v10, v10, 8, v9
    v_lshlrev_b32 v7, 10, v4
    v_lshl_add_u32 v7, v5, 3, v7
    s_lshl_b32 s22, s20, 6
    v_add_u32 v7, s22, v7
    v_lshlrev_b32 v6, 3, v4
    s_waitcnt lgkmcnt(0)
    buffer_load_dwordx4 v[48:51], v8, s[8:11], s25 offen
    s_barrier
    s_barrier
    ds_read_b64 v[40:41], v6 offset:36352
    ds_read_b64 v[42:43], v7 offset:32768
    ds_read_b64 v[44:45], v7 offset:36864
    s_mov_b32 s33, 49152
    s_mov_b32 s32, 0
    s_waitcnt lgkmcnt(0)
    v_lshrrev_b32 v11, 4, v40
    v_lshlrev_b32 v11, 7, v11
K5_FPOLL:
    buffer_load_dwordx4 v[12:15], v3, s[8:11], s21 offen sc1
    buffer_load_dwordx4 v[16:19], v3, s[8:11], s26 offen sc1
    buffer_load_dwordx4 v[20:23], v3, s[8:11], s27 offen sc1
    buffer_load_dwordx4 v[24:27], v3, s[8:11], s28 offen sc1
    buffer_load_dwordx4 v[28:31], v3, s[8:11], s29 offen sc1
    buffer_load_dwordx4 v[32:35], v3, s[8:11], s30 offen sc1
    buffer_load_dwordx4 v[36:39], v3, s[8:11], s31 offen sc1
    buffer_load_dword v46, v11, s[8:11], s33 offen sc1
    s_add_u32 s32, s32, 1
    s_waitcnt vmcnt(0)
    v_max3_u32 v46, v46, v12, v13
    v_max3_u32 v46, v46, v14, v15
    v_max3_u32 v46, v46, v16, v17
    v_max3_u32 v46, v46, v18, v19
    v_max3_u32 v46, v46, v20, v21
    v_max3_u32 v46, v46, v22, v23
    v_max3_u32 v46, v46, v24, v25
    v_max3_u32 v46, v46, v26, v27
    v_max3_u32 v46, v46, v28, v29
    v_max3_u32 v46, v46, v30, v31
    v_max3_u32 v46, v46, v32, v33
    v_max3_u32 v46, v46, v34, v35
    v_max3_u32 v46, v46, v36, v37
    v_max3_u32 v46, v46, v38, v39
    v_cmp_eq_u32 vcc, -1, v46
    s_cmp_gt_u32 s32, 0x100000
    s_cbranch_scc1 K5_FPX
    s_cbranch_vccnz K5_FPOLL
K5_FPX:
    v_pk_add_f32 v[16:17], v[16:17], v[20:21]
    v_pk_add_f32 v[18:19], v[18:19], v[22:23]
    v_pk_add_f32 v[24:25], v[24:25], v[28:29]
    v_pk_add_f32 v[26:27], v[26:27], v[30:31]
    v_pk_add_f32 v[32:33], v[32:33], v[36:37]
    v_pk_add_f32 v[34:35], v[34:35], v[38:39]
    v_pk_add_f32 v[12:13], v[12:13], v[16:17]
    v_pk_add_f32 v[14:15], v[14:15], v[18:19]
    v_pk_add_f32 v[12:13], v[12:13], v[24:25]
    v_pk_add_f32 v[14:15], v[14:15], v[26:27]
    v_pk_add_f32 v[12:13], v[12:13], v[32:33]
    v_pk_add_f32 v[14:15], v[14:15], v[34:35]
    v_mov_b32 v16, v12
    v_mov_b32 v17, v13
    v_mov_b32 v18, v14
    v_mov_b32 v19, v15
    v_permlane16_swap_b32 v12, v16
    v_permlane16_swap_b32 v13, v17
    v_permlane16_swap_b32 v14, v18
    v_permlane16_swap_b32 v15, v19
    v_pk_add_f32 v[12:13], v[12:13], v[16:17]
    v_pk_add_f32 v[14:15], v[14:15], v[18:19]
    v_mov_b32 v16, v12
    v_mov_b32 v17, v13
    v_mov_b32 v18, v14
    v_mov_b32 v19, v15
    v_permlane32_swap_b32 v12, v16
    v_permlane32_swap_b32 v13, v17
    v_permlane32_swap_b32 v14, v18
    v_permlane32_swap_b32 v15, v19
    v_pk_add_f32 v[12:13], v[12:13], v[16:17]
    v_pk_add_f32 v[14:15], v[14:15], v[18:19]
    ds_write_b128 v10, v[12:15] offset:38912
    v_lshlrev_b32 v72, 16, v42
    v_and_b32 v73, 0xffff0000, v42
    v_lshlrev_b32 v76, 16, v44
    v_and_b32 v77, 0xffff0000, v44
    v_lshlrev_b32 v74, 16, v43
    v_and_b32 v75, 0xffff0000, v43
    v_lshlrev_b32 v78, 16, v45
    v_and_b32 v79, 0xffff0000, v45
    v_lshlrev_b32 v40, 10, v40
    v_lshl_add_u32 v40, v5, 3, v40
    s_waitcnt lgkmcnt(0)
    s_barrier
    s_cmp_lg_u32 s24, 4
    s_cbranch_scc1 K5_FEND
    ds_read_b128 v[52:55], v9 offset:38912
    ds_read_b128 v[56:59], v9 offset:39168
    ds_read_b128 v[60:63], v9 offset:39424
    ds_read_b128 v[64:67], v9 offset:39680
    s_waitcnt lgkmcnt(0)
    v_pk_add_f32 v[52:53], v[52:53], v[60:61]
    v_pk_add_f32 v[54:55], v[54:55], v[62:63]
    v_pk_add_f32 v[56:57], v[56:57], v[64:65]
    v_pk_add_f32 v[58:59], v[58:59], v[66:67]
    v_pk_add_f32 v[52:53], v[52:53], v[56:57]
    v_pk_add_f32 v[54:55], v[54:55], v[58:59]
    v_cvt_pk_bf16_f32 v60, v52, v53
    v_cvt_pk_bf16_f32 v61, v54, v55
    v_lshlrev_b32 v52, 16, v60
    v_and_b32 v53, 0xffff0000, v60
    v_lshlrev_b32 v54, 16, v61
    v_and_b32 v55, 0xffff0000, v61
    v_mul_f32 v52, v52, v41
    v_mul_f32 v53, v53, v41
    v_mul_f32 v54, v54, v41
    v_mul_f32 v55, v55, v41
    v_cvt_pk_bf16_f32 v60, v52, v53
    v_cvt_pk_bf16_f32 v61, v54, v55
    v_lshlrev_b32 v52, 16, v60
    v_and_b32 v53, 0xffff0000, v60
    v_lshlrev_b32 v54, 16, v61
    v_and_b32 v55, 0xffff0000, v61
    v_add_f32 v52, v52, v72
    v_add_f32 v53, v53, v73
    v_add_f32 v54, v54, v74
    v_add_f32 v55, v55, v75
    v_cvt_pk_bf16_f32 v60, v52, v53
    v_cvt_pk_bf16_f32 v61, v54, v55
    v_lshlrev_b32 v52, 16, v60
    v_and_b32 v53, 0xffff0000, v60
    v_lshlrev_b32 v54, 16, v61
    v_and_b32 v55, 0xffff0000, v61
    v_mul_f32 v52, v52, v48
    v_mul_f32 v53, v53, v49
    v_mul_f32 v54, v54, v50
    v_mul_f32 v55, v55, v51
    v_cvt_pk_bf16_f32 v60, v52, v53
    v_cvt_pk_bf16_f32 v61, v54, v55
    v_lshlrev_b32 v52, 16, v60
    v_and_b32 v53, 0xffff0000, v60
    v_lshlrev_b32 v54, 16, v61
    v_and_b32 v55, 0xffff0000, v61
    v_add_f32 v52, v52, v76
    v_add_f32 v53, v53, v77
    v_add_f32 v54, v54, v78
    v_add_f32 v55, v55, v79
    v_cvt_pk_bf16_f32 v60, v52, v53
    v_cvt_pk_bf16_f32 v61, v54, v55
    s_mov_b64 exec, 0xffff
    buffer_store_dwordx2 v[60:61], v40, s[12:15], s22 offen
K5_FEND:
    s_endpgm
K5_MLP:
    s_and_b32 s3, s2, 7
    s_mul_i32 s3, s3, 14
    s_lshr_b32 s4, s2, 3
    s_add_u32 s3, s3, s4
    s_cmp_lt_u32 s24, 4
    s_cbranch_scc1 K5_SEL
    s_load_dwordx2 s[12:13], s[0:1], 40
    s_mov_b32 s14, 1835008
    s_mov_b32 s15, 0x20000
    s_load_dwordx2 s[16:17], s[0:1], 48
    s_mov_b32 s18, 1835008
    s_mov_b32 s19, 0x20000
    s_and_b32 s24, s24, 3
    v_lshrrev_b32 v3, 1, v1
    v_mul_u32_u24 v3, 3584, v3
    v_and_b32 v4, 1, v1
    v_lshl_add_u32 v3, v4, 4, v3
    s_mul_i32 s28, s24, 458752
    s_lshl_b32 s29, s3, 5
    s_add_u32 s28, s28, s29
    s_lshl_b32 s30, s24, 12
    s_waitcnt lgkmcnt(0)
    s_add_u32 m0, s30, 0
    s_add_u32 s32, s28, 0
    buffer_load_dwordx4 v3, s[12:15], s32 offen lds
    s_add_u32 m0, s30, 16384
    s_add_u32 s32, s28, 0
    buffer_load_dwordx4 v3, s[16:19], s32 offen lds
    s_add_u32 m0, s30, 1024
    s_add_u32 s32, s28, 114688
    buffer_load_dwordx4 v3, s[12:15], s32 offen lds
    s_add_u32 m0, s30, 17408
    s_add_u32 s32, s28, 114688
    buffer_load_dwordx4 v3, s[16:19], s32 offen lds
    s_add_u32 m0, s30, 2048
    s_add_u32 s32, s28, 229376
    buffer_load_dwordx4 v3, s[12:15], s32 offen lds
    s_add_u32 m0, s30, 18432
    s_add_u32 s32, s28, 229376
    buffer_load_dwordx4 v3, s[16:19], s32 offen lds
    s_add_u32 m0, s30, 3072
    s_add_u32 s32, s28, 344064
    buffer_load_dwordx4 v3, s[12:15], s32 offen lds
    s_add_u32 m0, s30, 19456
    s_add_u32 s32, s28, 344064
    buffer_load_dwordx4 v3, s[16:19], s32 offen lds
    v_lshlrev_b32 v8, 10, v4
    v_lshrrev_b32 v9, 4, v1
    v_lshl_add_u32 v8, v9, 4, v8
    s_lshl_b32 s36, s24, 8
    s_add_u32 s36, s36, 32768
    v_add_u32 v8, s36, v8
    v_lshlrev_b32 v10, 8, v9
    v_bfe_u32 v11, v1, 2, 2
    v_lshl_add_u32 v10, v11, 5, v10
    v_and_b32 v11, 3, v1
    v_lshl_add_u32 v10, v11, 3, v10
    v_add_u32 v10, s30, v10
    v_lshlrev_b32 v12, 6, v1
    s_lshl_b32 s37, s24, 4
    s_add_u32 s37, s37, 34816
    v_add_u32 v12, s37, v12
    s_barrier
    s_waitcnt vmcnt(0)
    ds_read_b64_tr_b16 v[32:33], v10 offset:0
    ds_read_b64_tr_b16 v[34:35], v10 offset:128
    ds_read_b64_tr_b16 v[48:49], v10 offset:16384
    ds_read_b64_tr_b16 v[50:51], v10 offset:16512
    ds_read_b64_tr_b16 v[36:37], v10 offset:1024
    ds_read_b64_tr_b16 v[38:39], v10 offset:1152
    ds_read_b64_tr_b16 v[52:53], v10 offset:17408
    ds_read_b64_tr_b16 v[54:55], v10 offset:17536
    ds_read_b64_tr_b16 v[40:41], v10 offset:2048
    ds_read_b64_tr_b16 v[42:43], v10 offset:2176
    ds_read_b64_tr_b16 v[56:57], v10 offset:18432
    ds_read_b64_tr_b16 v[58:59], v10 offset:18560
    s_waitcnt lgkmcnt(4)
    ds_read_b64_tr_b16 v[44:45], v10 offset:3072
    ds_read_b64_tr_b16 v[46:47], v10 offset:3200
    ds_read_b64_tr_b16 v[60:61], v10 offset:19456
    ds_read_b64_tr_b16 v[62:63], v10 offset:19584
    s_waitcnt lgkmcnt(0)
    s_barrier
    ds_read_b128 v[16:19], v8 offset:0
    ds_read_b128 v[20:23], v8 offset:64
    ds_read_b128 v[24:27], v8 offset:128
    ds_read_b128 v[28:31], v8 offset:192
    s_waitcnt lgkmcnt(3)
    v_mfma_f32_16x16x32_bf16 v[64:67], v[16:19], v[32:35], 0
    v_mfma_f32_16x16x32_bf16 v[68:71], v[16:19], v[48:51], 0
    s_waitcnt lgkmcnt(2)
    v_mfma_f32_16x16x32_bf16 v[64:67], v[20:23], v[36:39], v[64:67]
    v_mfma_f32_16x16x32_bf16 v[68:71], v[20:23], v[52:55], v[68:71]
    s_waitcnt lgkmcnt(1)
    v_mfma_f32_16x16x32_bf16 v[64:67], v[24:27], v[40:43], v[64:67]
    v_mfma_f32_16x16x32_bf16 v[68:71], v[24:27], v[56:59], v[68:71]
    s_waitcnt lgkmcnt(0)
    v_mfma_f32_16x16x32_bf16 v[64:67], v[28:31], v[44:47], v[64:67]
    v_mfma_f32_16x16x32_bf16 v[68:71], v[28:31], v[60:63], v[68:71]
    s_mov_b64 exec, 0xffff
    s_nop 6
    ds_write_b64 v12, v[64:65]
    ds_write_b64 v12, v[68:69] offset:8
    s_waitcnt lgkmcnt(0)
    s_barrier
    s_endpgm
K5_SEL:
    s_load_dwordx2 s[20:21], s[0:1], 56
    s_mov_b32 s22, 1835008
    s_mov_b32 s23, 0x20000
    v_and_b32 v7, 127, v0
    v_lshlrev_b32 v6, 4, v7
    s_mov_b32 s33, 6144
    buffer_load_dwordx4 v[52:55], v6, s[8:11], s33 offen
    buffer_load_dwordx4 v[56:59], v6, s[8:11], s33 offen offset:2048
    v_lshlrev_b32 v5, 2, v0
    s_lshl_b32 s31, s3, 14
    s_cmp_lt_u32 s2, 112
    s_cselect_b32 s22, s22, 0
    s_cselect_b32 s31, s31, 0
    v_lshlrev_b32 v61, 3, v0
    v_add_u32 v64, 0, v61
    v_add_u32 v65, 1, v61
    v_add_u32 v66, 2, v61
    v_add_u32 v67, 3, v61
    v_add_u32 v68, 4, v61
    v_add_u32 v69, 5, v61
    v_add_u32 v70, 6, v61
    v_add_u32 v71, 7, v61
    s_mov_b32 s34, 0xfffff800
    s_mov_b32 s35, 0x3b000000
    s_lshl_b32 s36, s24, 3
    s_add_u32 s36, s36, 36096
    v_mov_b32 v76, s36
    v_mov_b32 v77, 36096
    v_add_u32 v83, 32768, v61
    v_and_b32 v84, 15, v1
    v_lshlrev_b32 v84, 6, v84
    s_waitcnt vmcnt(2)
    v_add_f32 v33, v140, v141
    v_add_f32 v32, v142, v143
    v_mul_f32 v34, 0xbb000000, v32
    v_mov_b32 v35, 0x3727c5ac
    v_mul_f32 v16, v112, v112
    v_mul_f32 v17, v113, v113
    v_mul_f32 v18, v114, v114
    v_mul_f32 v19, v115, v115
    v_mul_f32 v20, v116, v116
    v_mul_f32 v21, v117, v117
    v_mul_f32 v22, v118, v118
    v_mul_f32 v23, v119, v119
    v_fma_f32 v16, -v16, s35, v120
    v_fma_f32 v17, -v17, s35, v121
    v_fma_f32 v18, -v18, s35, v122
    v_fma_f32 v19, -v19, s35, v123
    v_fma_f32 v20, -v20, s35, v124
    v_fma_f32 v21, -v21, s35, v125
    v_fma_f32 v22, -v22, s35, v126
    v_fma_f32 v23, -v23, s35, v127
    v_fma_f32 v16, v16, s35, v35
    v_fma_f32 v17, v17, s35, v35
    v_fma_f32 v18, v18, s35, v35
    v_fma_f32 v19, v19, s35, v35
    v_fma_f32 v20, v20, s35, v35
    v_fma_f32 v21, v21, s35, v35
    v_fma_f32 v22, v22, s35, v35
    v_fma_f32 v23, v23, s35, v35
    v_rsq_f32 v16, v16
    v_rsq_f32 v17, v17
    v_rsq_f32 v18, v18
    v_rsq_f32 v19, v19
    v_rsq_f32 v20, v20
    v_rsq_f32 v21, v21
    v_rsq_f32 v22, v22
    v_rsq_f32 v23, v23
    v_fma_f32 v8, v112, v34, v128
    v_fma_f32 v9, v113, v34, v129
    v_fma_f32 v10, v114, v34, v130
    v_fma_f32 v11, v115, v34, v131
    v_fma_f32 v12, v116, v34, v132
    v_fma_f32 v13, v117, v34, v133
    v_fma_f32 v14, v118, v34, v134
    v_fma_f32 v15, v119, v34, v135
    v_mul_f32 v8, v8, v16
    v_mul_f32 v9, v9, v17
    v_mul_f32 v10, v10, v18
    v_mul_f32 v11, v11, v19
    v_mul_f32 v12, v12, v20
    v_mul_f32 v13, v13, v21
    v_mul_f32 v14, v14, v22
    v_mul_f32 v15, v15, v23
    v_and_or_b32 v64, v8, s34, v64
    v_and_or_b32 v65, v9, s34, v65
    v_and_or_b32 v66, v10, s34, v66
    v_and_or_b32 v67, v11, s34, v67
    v_and_or_b32 v68, v12, s34, v68
    v_and_or_b32 v69, v13, s34, v69
    v_and_or_b32 v70, v14, s34, v70
    v_and_or_b32 v71, v15, s34, v71
    v_max_f32 v72, v64, v65
    v_min_f32 v73, v64, v65
    v_med3_f32 v73, v72, v73, v66
    v_max_f32 v72, v72, v66
    v_med3_f32 v73, v72, v73, v67
    v_max_f32 v72, v72, v67
    v_med3_f32 v73, v72, v73, v68
    v_max_f32 v72, v72, v68
    v_med3_f32 v73, v72, v73, v69
    v_max_f32 v72, v72, v69
    v_med3_f32 v73, v72, v73, v70
    v_max_f32 v72, v72, v70
    v_med3_f32 v73, v72, v73, v71
    v_max_f32 v72, v72, v71
    s_nop 1
    v_min_f32_dpp v74, v72, v72 quad_perm:[1,0,3,2] row_mask:0xf bank_mask:0xf
    v_max_f32_dpp v72, v72, v72 quad_perm:[1,0,3,2] row_mask:0xf bank_mask:0xf
    v_max_f32_dpp v73, v73, v73 quad_perm:[1,0,3,2] row_mask:0xf bank_mask:0xf
    v_max_f32 v73, v73, v74
    v_min_f32_dpp v74, v72, v72 quad_perm:[2,3,0,1] row_mask:0xf bank_mask:0xf
    v_max_f32_dpp v72, v72, v72 quad_perm:[2,3,0,1] row_mask:0xf bank_mask:0xf
    v_max_f32_dpp v73, v73, v73 quad_perm:[2,3,0,1] row_mask:0xf bank_mask:0xf
    v_max_f32 v73, v73, v74
    v_min_f32_dpp v74, v72, v72 row_ror:4 row_mask:0xf bank_mask:0xf
    v_max_f32_dpp v72, v72, v72 row_ror:4 row_mask:0xf bank_mask:0xf
    v_max_f32_dpp v73, v73, v73 row_ror:4 row_mask:0xf bank_mask:0xf
    v_max_f32 v73, v73, v74
    v_min_f32_dpp v74, v72, v72 row_ror:8 row_mask:0xf bank_mask:0xf
    v_max_f32_dpp v72, v72, v72 row_ror:8 row_mask:0xf bank_mask:0xf
    v_max_f32_dpp v73, v73, v73 row_ror:8 row_mask:0xf bank_mask:0xf
    v_max_f32 v73, v73, v74
    v_lshrrev_b32 v76, 4, v0
    v_lshlrev_b32 v76, 3, v76
    v_cmp_gt_u32 vcc, 128, v0
    s_mov_b32 s35, 13631488
    ds_write_b64 v76, v[72:73] offset:36096
    v_and_b32 v76, 15, v1
    v_lshlrev_b32 v77, 3, v76
    s_waitcnt lgkmcnt(0)
    s_barrier
    ds_read_b64 v[72:73], v77 offset:36096
    s_waitcnt lgkmcnt(0)
    v_min_f32_dpp v74, v72, v72 quad_perm:[1,0,3,2] row_mask:0xf bank_mask:0xf
    v_max_f32_dpp v72, v72, v72 quad_perm:[1,0,3,2] row_mask:0xf bank_mask:0xf
    v_max_f32_dpp v73, v73, v73 quad_perm:[1,0,3,2] row_mask:0xf bank_mask:0xf
    v_max_f32 v73, v73, v74
    v_min_f32_dpp v74, v72, v72 quad_perm:[2,3,0,1] row_mask:0xf bank_mask:0xf
    v_max_f32_dpp v72, v72, v72 quad_perm:[2,3,0,1] row_mask:0xf bank_mask:0xf
    v_max_f32_dpp v73, v73, v73 quad_perm:[2,3,0,1] row_mask:0xf bank_mask:0xf
    v_max_f32 v73, v73, v74
    v_min_f32_dpp v74, v72, v72 row_ror:4 row_mask:0xf bank_mask:0xf
    v_max_f32_dpp v72, v72, v72 row_ror:4 row_mask:0xf bank_mask:0xf
    v_max_f32_dpp v73, v73, v73 row_ror:4 row_mask:0xf bank_mask:0xf
    v_max_f32 v73, v73, v74
    v_min_f32_dpp v74, v72, v72 row_ror:8 row_mask:0xf bank_mask:0xf
    v_max_f32_dpp v72, v72, v72 row_ror:8 row_mask:0xf bank_mask:0xf
    v_max_f32_dpp v73, v73, v73 row_ror:8 row_mask:0xf bank_mask:0xf
    v_max_f32 v73, v73, v74
    v_cndmask_b32 v74, v73, v72, vcc
    v_and_b32 v74, 0x7ff, v74
    v_lshlrev_b32 v75, 10, v74
    v_lshl_add_u32 v75, v7, 3, v75
    buffer_load_dwordx2 v[78:79], v75, s[8:11], s35 offen
    v_lshlrev_b32 v76, 2, v74
    buffer_load_dword v80, v76, s[8:11], s25 offen
    buffer_load_dword v81, v76, s[8:11], s26 offen
    buffer_load_dword v82, v76, s[8:11], s27 offen
    s_add_u32 s32, s31, 0
    buffer_load_dword v36, v5, s[20:23], s32 offen offset:0
    buffer_load_dword v37, v5, s[20:23], s32 offen offset:1024
    buffer_load_dword v38, v5, s[20:23], s32 offen offset:2048
    buffer_load_dword v39, v5, s[20:23], s32 offen offset:3072
    s_add_u32 s32, s31, 4096
    buffer_load_dword v40, v5, s[20:23], s32 offen offset:0
    buffer_load_dword v41, v5, s[20:23], s32 offen offset:1024
    buffer_load_dword v42, v5, s[20:23], s32 offen offset:2048
    buffer_load_dword v43, v5, s[20:23], s32 offen offset:3072
    s_add_u32 s32, s31, 8192
    buffer_load_dword v44, v5, s[20:23], s32 offen offset:0
    buffer_load_dword v45, v5, s[20:23], s32 offen offset:1024
    buffer_load_dword v46, v5, s[20:23], s32 offen offset:2048
    buffer_load_dword v47, v5, s[20:23], s32 offen offset:3072
    s_add_u32 s32, s31, 12288
    buffer_load_dword v48, v5, s[20:23], s32 offen offset:0
    buffer_load_dword v49, v5, s[20:23], s32 offen offset:1024
    buffer_load_dword v50, v5, s[20:23], s32 offen offset:2048
    buffer_load_dword v51, v5, s[20:23], s32 offen offset:3072
    s_waitcnt vmcnt(16)
    v_lshlrev_b32 v88, 16, v78
    v_and_b32 v89, 0xffff0000, v78
    v_lshlrev_b32 v90, 16, v79
    v_and_b32 v91, 0xffff0000, v79
    v_mul_f32 v80, 0x3b000000, v80
    v_mul_f32 v81, 0x3b000000, v81
    v_fma_f32 v81, -v80, v80, v81
    v_max_f32 v81, 0, v81
    v_cvt_pk_bf16_f32 v80, v80, v80
    v_cvt_pk_bf16_f32 v81, v81, v81
    v_and_b32 v80, 0xffff0000, v80
    v_and_b32 v81, 0xffff0000, v81
    v_add_f32 v81, 0x3727c5ac, v81
    v_cvt_pk_bf16_f32 v81, v81, v81
    v_and_b32 v81, 0xffff0000, v81
    v_sqrt_f32 v81, v81
    s_nop 0
    v_cvt_pk_bf16_f32 v81, v81, v81
    v_and_b32 v81, 0xffff0000, v81
    v_rcp_f32 v81, v81
    s_nop 0
    v_sub_f32 v92, v88, v80
    v_sub_f32 v93, v89, v80
    v_sub_f32 v94, v90, v80
    v_sub_f32 v95, v91, v80
    v_cvt_pk_bf16_f32 v96, v92, v93
    v_cvt_pk_bf16_f32 v97, v94, v95
    v_lshlrev_b32 v92, 16, v96
    v_and_b32 v93, 0xffff0000, v96
    v_lshlrev_b32 v94, 16, v97
    v_and_b32 v95, 0xffff0000, v97
    v_mul_f32 v92, v92, v81
    v_mul_f32 v93, v93, v81
    v_mul_f32 v94, v94, v81
    v_mul_f32 v95, v95, v81
    v_cvt_pk_bf16_f32 v96, v92, v93
    v_cvt_pk_bf16_f32 v97, v94, v95
    v_lshlrev_b32 v92, 16, v96
    v_and_b32 v93, 0xffff0000, v96
    v_lshlrev_b32 v94, 16, v97
    v_and_b32 v95, 0xffff0000, v97
    v_pk_mul_f32 v[92:93], v[92:93], v[56:57]
    v_pk_mul_f32 v[94:95], v[94:95], v[58:59]
    v_cvt_pk_bf16_f32 v96, v92, v93
    v_cvt_pk_bf16_f32 v97, v94, v95
    v_lshlrev_b32 v92, 16, v96
    v_and_b32 v93, 0xffff0000, v96
    v_lshlrev_b32 v94, 16, v97
    v_and_b32 v95, 0xffff0000, v97
    v_pk_add_f32 v[92:93], v[92:93], v[52:53]
    v_pk_add_f32 v[94:95], v[94:95], v[54:55]
    v_cvt_pk_bf16_f32 v96, v92, v93
    v_cvt_pk_bf16_f32 v97, v94, v95
    ds_write_b64 v83, v[96:97]
    s_cmp_lt_u32 s2, 112
    s_cbranch_scc1 K5_NFIN
    ds_write_b64 v83, v[78:79] offset:4096
    v_fma_f32 v82, -v80, v32, v82
    v_fma_f32 v82, v82, v81, v33
    v_cvt_pk_bf16_f32 v82, v82, v82
    v_and_b32 v82, 0xffff0000, v82
    v_mul_f32 v75, 0xbfb8aa3b, v82
    v_exp_f32 v75, v75
    v_lshrrev_b32 v76, 7, v0
    v_add_f32 v75, 1.0, v75
    v_rcp_f32 v75, v75
    v_lshlrev_b32 v76, 3, v76
    v_cvt_pk_bf16_f32 v75, v75, v75
    v_and_b32 v75, 0xffff0000, v75
    ds_write_b64 v76, v[74:75] offset:36352
    s_waitcnt lgkmcnt(0)
    s_barrier
    s_endpgm
K5_NFIN:
    s_waitcnt lgkmcnt(0)
    s_barrier
    v_fma_f32 v82, -v80, v32, v82
    v_fma_f32 v82, v82, v81, v33
    s_waitcnt vmcnt(0)
    v_lshlrev_b32 v112, 16, v36
    v_and_b32 v113, 0xffff0000, v36
    v_lshlrev_b32 v114, 16, v37
    v_and_b32 v115, 0xffff0000, v37
    v_lshlrev_b32 v116, 16, v38
    v_and_b32 v117, 0xffff0000, v38
    v_lshlrev_b32 v118, 16, v39
    v_and_b32 v119, 0xffff0000, v39
    v_lshlrev_b32 v120, 16, v40
    v_and_b32 v121, 0xffff0000, v40
    v_lshlrev_b32 v122, 16, v41
    v_and_b32 v123, 0xffff0000, v41
    v_lshlrev_b32 v124, 16, v42
    v_and_b32 v125, 0xffff0000, v42
    v_lshlrev_b32 v126, 16, v43
    v_and_b32 v127, 0xffff0000, v43
    v_lshlrev_b32 v128, 16, v44
    v_and_b32 v129, 0xffff0000, v44
    v_lshlrev_b32 v130, 16, v45
    v_and_b32 v131, 0xffff0000, v45
    v_lshlrev_b32 v132, 16, v46
    v_and_b32 v133, 0xffff0000, v46
    v_lshlrev_b32 v134, 16, v47
    v_and_b32 v135, 0xffff0000, v47
    v_lshlrev_b32 v136, 16, v48
    v_and_b32 v137, 0xffff0000, v48
    v_lshlrev_b32 v138, 16, v49
    v_and_b32 v139, 0xffff0000, v49
    v_lshlrev_b32 v140, 16, v50
    v_and_b32 v141, 0xffff0000, v50
    v_lshlrev_b32 v142, 16, v51
    v_and_b32 v143, 0xffff0000, v51
    v_lshlrev_b32 v98, 3, v0
    s_lshl_b32 s37, s2, 12
    s_add_u32 s37, s37, 65536
    s_barrier
    ds_read_b128 v[8:11], v84 offset:34816
    ds_read_b128 v[12:15], v84 offset:34832
    ds_read_b128 v[16:19], v84 offset:34848
    ds_read_b128 v[20:23], v84 offset:34864
    s_waitcnt lgkmcnt(2)
    v_pk_add_f32 v[8:9], v[8:9], v[12:13]
    v_pk_add_f32 v[10:11], v[10:11], v[14:15]
    s_waitcnt lgkmcnt(0)
    v_pk_add_f32 v[16:17], v[16:17], v[20:21]
    v_pk_add_f32 v[18:19], v[18:19], v[22:23]
    v_pk_add_f32 v[8:9], v[8:9], v[16:17]
    v_pk_add_f32 v[10:11], v[10:11], v[18:19]
    v_cvt_pk_bf16_f32 v8, v8, v8
    v_cvt_pk_bf16_f32 v9, v9, v9
    v_cvt_pk_bf16_f32 v10, v10, v10
    v_cvt_pk_bf16_f32 v11, v11, v11
    v_and_b32 v8, 0xffff0000, v8
    v_and_b32 v9, 0xffff0000, v9
    v_and_b32 v10, 0xffff0000, v10
    v_and_b32 v11, 0xffff0000, v11
    v_mul_f32 v12, 0xbfb8aa3b, v8
    v_mul_f32 v13, 0xbfb8aa3b, v9
    v_exp_f32 v12, v12
    v_exp_f32 v13, v13
    s_nop 0
    v_add_f32 v12, 1.0, v12
    v_add_f32 v13, 1.0, v13
    v_rcp_f32 v12, v12
    v_rcp_f32 v13, v13
    s_nop 0
    v_mul_f32 v8, v8, v12
    v_mul_f32 v9, v9, v13
    v_cvt_pk_bf16_f32 v8, v8, v8
    v_cvt_pk_bf16_f32 v9, v9, v9
    v_and_b32 v8, 0xffff0000, v8
    v_and_b32 v9, 0xffff0000, v9
    v_mul_f32 v8, v8, v10
    v_mul_f32 v9, v9, v11
    v_cvt_pk_bf16_f32 v8, v8, v8
    v_cvt_pk_bf16_f32 v9, v9, v9
    v_and_b32 v8, 0xffff0000, v8
    v_and_b32 v9, 0xffff0000, v9
    s_nop 0
    v_readlane_b32 s40, v8, 0
    v_readlane_b32 s41, v9, 0
    v_readlane_b32 s42, v8, 1
    v_readlane_b32 s43, v9, 1
    v_readlane_b32 s44, v8, 2
    v_readlane_b32 s45, v9, 2
    v_readlane_b32 s46, v8, 3
    v_readlane_b32 s47, v9, 3
    v_readlane_b32 s48, v8, 4
    v_readlane_b32 s49, v9, 4
    v_readlane_b32 s50, v8, 5
    v_readlane_b32 s51, v9, 5
    v_readlane_b32 s52, v8, 6
    v_readlane_b32 s53, v9, 6
    v_readlane_b32 s54, v8, 7
    v_readlane_b32 s55, v9, 7
    v_readlane_b32 s56, v8, 8
    v_readlane_b32 s57, v9, 8
    v_readlane_b32 s58, v8, 9
    v_readlane_b32 s59, v9, 9
    v_readlane_b32 s60, v8, 10
    v_readlane_b32 s61, v9, 10
    v_readlane_b32 s62, v8, 11
    v_readlane_b32 s63, v9, 11
    v_readlane_b32 s64, v8, 12
    v_readlane_b32 s65, v9, 12
    v_readlane_b32 s66, v8, 13
    v_readlane_b32 s67, v9, 13
    v_readlane_b32 s68, v8, 14
    v_readlane_b32 s69, v9, 14
    v_readlane_b32 s70, v8, 15
    v_readlane_b32 s71, v9, 15
    s_nop 0
    v_pk_mul_f32 v[108:109], v[112:113], s[40:41] op_sel:[0,0] op_sel_hi:[1,0]
    v_pk_mul_f32 v[110:111], v[112:113], s[40:41] op_sel:[0,1] op_sel_hi:[1,1]
    v_pk_fma_f32 v[108:109], v[114:115], s[42:43], v[108:109] op_sel:[0,0,0] op_sel_hi:[1,0,1]
    v_pk_fma_f32 v[110:111], v[114:115], s[42:43], v[110:111] op_sel:[0,1,0] op_sel_hi:[1,1,1]
    v_pk_fma_f32 v[108:109], v[116:117], s[44:45], v[108:109] op_sel:[0,0,0] op_sel_hi:[1,0,1]
    v_pk_fma_f32 v[110:111], v[116:117], s[44:45], v[110:111] op_sel:[0,1,0] op_sel_hi:[1,1,1]
    v_pk_fma_f32 v[108:109], v[118:119], s[46:47], v[108:109] op_sel:[0,0,0] op_sel_hi:[1,0,1]
    v_pk_fma_f32 v[110:111], v[118:119], s[46:47], v[110:111] op_sel:[0,1,0] op_sel_hi:[1,1,1]
    v_pk_fma_f32 v[108:109], v[120:121], s[48:49], v[108:109] op_sel:[0,0,0] op_sel_hi:[1,0,1]
    v_pk_fma_f32 v[110:111], v[120:121], s[48:49], v[110:111] op_sel:[0,1,0] op_sel_hi:[1,1,1]
    v_pk_fma_f32 v[108:109], v[122:123], s[50:51], v[108:109] op_sel:[0,0,0] op_sel_hi:[1,0,1]
    v_pk_fma_f32 v[110:111], v[122:123], s[50:51], v[110:111] op_sel:[0,1,0] op_sel_hi:[1,1,1]
    v_pk_fma_f32 v[108:109], v[124:125], s[52:53], v[108:109] op_sel:[0,0,0] op_sel_hi:[1,0,1]
    v_pk_fma_f32 v[110:111], v[124:125], s[52:53], v[110:111] op_sel:[0,1,0] op_sel_hi:[1,1,1]
    v_pk_fma_f32 v[108:109], v[126:127], s[54:55], v[108:109] op_sel:[0,0,0] op_sel_hi:[1,0,1]
    v_pk_fma_f32 v[110:111], v[126:127], s[54:55], v[110:111] op_sel:[0,1,0] op_sel_hi:[1,1,1]
    v_pk_fma_f32 v[108:109], v[128:129], s[56:57], v[108:109] op_sel:[0,0,0] op_sel_hi:[1,0,1]
    v_pk_fma_f32 v[110:111], v[128:129], s[56:57], v[110:111] op_sel:[0,1,0] op_sel_hi:[1,1,1]
    v_pk_fma_f32 v[108:109], v[130:131], s[58:59], v[108:109] op_sel:[0,0,0] op_sel_hi:[1,0,1]
    v_pk_fma_f32 v[110:111], v[130:131], s[58:59], v[110:111] op_sel:[0,1,0] op_sel_hi:[1,1,1]
    v_pk_fma_f32 v[108:109], v[132:133], s[60:61], v[108:109] op_sel:[0,0,0] op_sel_hi:[1,0,1]
    v_pk_fma_f32 v[110:111], v[132:133], s[60:61], v[110:111] op_sel:[0,1,0] op_sel_hi:[1,1,1]
    v_pk_fma_f32 v[108:109], v[134:135], s[62:63], v[108:109] op_sel:[0,0,0] op_sel_hi:[1,0,1]
    v_pk_fma_f32 v[110:111], v[134:135], s[62:63], v[110:111] op_sel:[0,1,0] op_sel_hi:[1,1,1]
    v_pk_fma_f32 v[108:109], v[136:137], s[64:65], v[108:109] op_sel:[0,0,0] op_sel_hi:[1,0,1]
    v_pk_fma_f32 v[110:111], v[136:137], s[64:65], v[110:111] op_sel:[0,1,0] op_sel_hi:[1,1,1]
    v_pk_fma_f32 v[108:109], v[138:139], s[66:67], v[108:109] op_sel:[0,0,0] op_sel_hi:[1,0,1]
    v_pk_fma_f32 v[110:111], v[138:139], s[66:67], v[110:111] op_sel:[0,1,0] op_sel_hi:[1,1,1]
    v_pk_fma_f32 v[108:109], v[140:141], s[68:69], v[108:109] op_sel:[0,0,0] op_sel_hi:[1,0,1]
    v_pk_fma_f32 v[110:111], v[140:141], s[68:69], v[110:111] op_sel:[0,1,0] op_sel_hi:[1,1,1]
    v_pk_fma_f32 v[108:109], v[142:143], s[70:71], v[108:109] op_sel:[0,0,0] op_sel_hi:[1,0,1]
    v_pk_fma_f32 v[110:111], v[142:143], s[70:71], v[110:111] op_sel:[0,1,0] op_sel_hi:[1,1,1]
    v_min_u32 v108, 0xfffffffe, v108
    v_min_u32 v109, 0xfffffffe, v109
    v_min_u32 v110, 0xfffffffe, v110
    v_min_u32 v111, 0xfffffffe, v111
    buffer_store_dwordx2 v[108:109], v98, s[8:11], s37 offen sc1
    buffer_store_dwordx2 v[110:111], v98, s[8:11], s37 offen offset:2048 sc1
K5_NOSEL:
    s_endpgm
K5_END:
    s_endpgm
K_CODE_END:
.section .rodata,"a"
.p2align 6
.amdhsa_kernel k2_kernel
  .amdhsa_next_free_vgpr 168
  .amdhsa_next_free_sgpr 80
  .amdhsa_accum_offset 168
  .amdhsa_group_segment_fixed_size 0
  .amdhsa_kernarg_size 104
  .amdhsa_user_sgpr_count 2
  .amdhsa_user_sgpr_kernarg_segment_ptr 1
  .amdhsa_system_sgpr_workgroup_id_x 1
.end_amdhsa_kernel
.p2align 6
.amdhsa_kernel k5_kernel
  .amdhsa_next_free_vgpr 144
  .amdhsa_next_free_sgpr 80
  .amdhsa_accum_offset 144
  .amdhsa_group_segment_fixed_size 0
  .amdhsa_kernarg_size 104
  .amdhsa_user_sgpr_count 2
  .amdhsa_user_sgpr_kernarg_segment_ptr 1
  .amdhsa_system_sgpr_workgroup_id_x 1
  .amdhsa_float_denorm_mode_32 3
.end_amdhsa_kernel
```
